```python
import torch

def _softmax(x, axis=-1):
    return torch.softmax(x, dim=axis)
def _gelu(x):
    return torch.nn.functional.gelu(x, approximate="tanh")
def _silu(x):
    return torch.nn.functional.silu(x)
def _sigmoid(x):
    return torch.sigmoid(x)
def _layernorm(x, axis=-1, eps=1e-5):
    m = x.mean(dim=axis, keepdim=True)
    v = x.var(dim=axis, keepdim=True, unbiased=False)
    return (x - m) / torch.sqrt(v + eps)
def _scatter_add(tgt, idx, src, axis=0):
    return tgt.clone().index_add_(axis, idx, src)
def _segment_sum(src, seg, n):
    out = torch.zeros((n,) + src.shape[1:], dtype=src.dtype)
    return out.index_add_(0, seg, src)
def _pad(x, pw):
    flat = tuple(v for pair in reversed(pw) for v in pair)
    return torch.nn.functional.pad(x, flat)

kernel_name = 'gather_scatter__mpnn_edge_mlp__graph'

def setup_inputs():

    _w = (lambda a: (lambda t: t.to(torch.bfloat16) if t.is_floating_point() else t)(torch.as_tensor(a)))
    N, deg, D, De = 12500, 64, 64, max(0, 1)
    E = N * deg
    return {
        "x": _w((lambda *s: torch.randn(*s, dtype=torch.bfloat16) * 0.05)(N, D)),
        "e_attr": _w((lambda *s: torch.randn(*s, dtype=torch.bfloat16) * 0.4)(E, De)),
        "src": _w((lambda lo, hi, *s: torch.randint(lo, hi, s))(0, N, E).to(torch.int64)),
        "dst": _w((lambda lo, hi, *s: torch.randint(lo, hi, s))(0, N, E).to(torch.int64)),
        "w_msg": _w((lambda *s: torch.randn(*s, dtype=torch.bfloat16) * 0.4)(2 * D + De, D)),
        "w_upd": _w((lambda *s: torch.randn(*s, dtype=torch.bfloat16) * 0.05)(2 * D, D)),
    }

def reference(x, e_attr, src, dst, w_msg, w_upd):
    N, D = x.shape
    m_in = torch.concatenate([x[src], x[dst], e_attr], axis=-1)
    msg = _silu(m_in @ w_msg)
    agg = _segment_sum(msg, dst, N)
    return _silu(torch.concatenate([x, agg], axis=-1) @ w_upd)
```

```asm
; @launch grid=(256,1,1) block=(512,1,1) lds=163520
.amdgcn_target "amdgcn-amd-amdhsa--gfx950"
.text
.globl gather_scatter__mpnn_edge_mlp__graph_kernel
.p2align 8
.type gather_scatter__mpnn_edge_mlp__graph_kernel,@function
gather_scatter__mpnn_edge_mlp__graph_kernel:
    s_cmpk_ge_u32 s2, 256
    s_cbranch_scc1 L_END
    s_load_dwordx16 s[20:35], s[0:1], 0
    s_load_dwordx2 s[8:9], s[0:1], 64
    s_memrealtime s[46:47]
    s_getpc_b64 s[48:49]
L_PC:
    v_lshrrev_b32 v218, 6, v0
    s_and_b32 s50, s2, 0x78
    v_add_lshl_u32 v224, v218, s50, 7
    v_readfirstlane_b32 s3, v218
    global_load_dword v254, v224, s[48:49]
    v_lshlrev_b32 v247, 4, v0
    s_lshl_b32 s51, s3, 10
    s_add_u32 m0, s51, 27824
    s_add_u32 s48, s48, L_TAB-L_PC
    s_addc_u32 s49, s49, 0
    global_load_lds_dwordx4 v247, s[48:49]
    v_and_b32 v25, 63, v0
    v_lshlrev_b32 v221, 2, v0
    v_mov_b32 v253, 0
    ds_write_b32 v221, v253 offset:9008
    s_mul_i32 s42, s2, 784
    v_mad_u32_u24 v219, v218, 49, v25
    s_mov_b32 exec_hi, 0x1ffff
    v_add_lshl_u32 v220, v219, s42, 3
    v_cmp_gt_u32 vcc, 1596864, v220
    v_lshlrev_b32 v219, 1, v220
    s_mov_b64 s[38:39], vcc
    v_add_u32 v219, 3136, v219
    v_cmpx_gt_u32 vcc, 1600000, v220
    s_waitcnt lgkmcnt(0)
    global_load_dwordx4 v[106:109], v219, s[26:27] offset:-3136
    s_mov_b64 exec, s[38:39]
    global_load_dwordx4 v[110:113], v219, s[26:27] offset:3136
    s_barrier
    global_load_dwordx4 v[118:121], v219, s[24:25] offset:3136
    global_load_dwordx2 v[124:125], v220, s[22:23] offset:3136
    s_mov_b64 exec, vcc
    global_load_dwordx4 v[114:117], v219, s[24:25] offset:-3136
    global_load_dwordx2 v[122:123], v220, s[22:23]
    s_mov_b64 s[36:37], vcc
    s_bitset1_b32 s46, 31
    s_or_b32 s43, s2, s3
    s_cselect_b64 exec, 0, 1
    v_mov_b32 v223, s46
    global_store_dword v253, v223, s[34:35] sc1
    s_mov_b64 exec, -1
    s_bitcmp1_b32 s2, 7
    s_cselect_b64 s[48:49], s[30:31], s[28:29]
    s_cselect_b32 s50, 0, 128
    v_add_u32 v224, s50, v224
    global_load_dword v254, v224, s[48:49]
    s_mov_b32 s42, s51
    s_and_b32 s4, s2, 7
    s_lshl_b32 s4, s4, 5
    s_lshr_b32 s7, s2, 3
    s_add_u32 s4, s4, s7
    s_mul_i32 s5, s4, 49
    v_lshrrev_b32 v227, 3, v0
    v_lshlrev_b32 v252, 2, v25
    v_lshlrev_b32 v222, 4, v25
    v_mul_u32_u24 v63, 448, v25
    v_add_u32 v63, 141568, v63
    v_mov_b32 v62, 12500
    s_cmp_eq_u32 s3, 0
    s_cselect_b64 exec, -1, 0
    ds_write_b32 v252, v62 offset:8320
    ds_write_b32 v252, v253 offset:8352
    ds_write_b32 v252, v63 offset:8336
    ds_write_b32 v253, v253 offset:8868
    s_mov_b64 exec, -1
    s_mov_b32 s10, 0x628000
    s_mov_b32 s11, 0x20000
    s_lshl_b32 s54, s3, 6
    s_add_u32 s54, s54, 16384
    v_add_u32 v178, s54, v222
    s_mul_i32 s43, s2, 16768
    s_add_u32 s43, s43, 0x210000
    s_add_u32 s55, s43, 8192
    s_cmp_lt_u32 s3, 6
    s_cselect_b32 s56, 15, 0
    s_lshl_b32 s57, s2, 11
    s_add_u32 s57, s57, 0x190000
    s_mov_b32 s46, 87652394
    s_movk_i32 s47, -49
    v_mov_b32 v218, 1
    s_mov_b64 exec, s[36:37]
    s_waitcnt vmcnt(7)
    v_mul_hi_u32 v126, v106, s46
    v_mul_hi_u32 v127, v107, s46
    v_mul_hi_u32 v128, v108, s46
    v_mul_hi_u32 v129, v109, s46
    v_lshlrev_b32 v126, 2, v126
    ds_add_rtn_u32 v138, v126, v218 offset:9008
    v_lshlrev_b32 v127, 2, v127
    ds_add_rtn_u32 v139, v127, v218 offset:9008
    v_lshlrev_b32 v128, 2, v128
    ds_add_rtn_u32 v140, v128, v218 offset:9008
    v_lshlrev_b32 v129, 2, v129
    ds_add_rtn_u32 v141, v129, v218 offset:9008
    s_mov_b64 exec, s[38:39]
    s_waitcnt vmcnt(6)
    v_mul_hi_u32 v130, v110, s46
    v_mul_hi_u32 v131, v111, s46
    v_mul_hi_u32 v132, v112, s46
    v_mul_hi_u32 v133, v113, s46
    v_lshlrev_b32 v130, 2, v130
    ds_add_rtn_u32 v142, v130, v218 offset:9008
    v_lshlrev_b32 v131, 2, v131
    ds_add_rtn_u32 v143, v131, v218 offset:9008
    v_lshlrev_b32 v132, 2, v132
    ds_add_rtn_u32 v144, v132, v218 offset:9008
    v_lshlrev_b32 v133, 2, v133
    ds_add_rtn_u32 v145, v133, v218 offset:9008
    s_mov_b64 exec, -1
    v_xor_b32 v225, v227, v0
    v_and_b32 v225, 7, v225
    v_add_u32 v226, s5, v227
    v_min_u32 v226, 12499, v226
    v_lshlrev_b32 v226, 3, v226
    s_add_u32 m0, s42, 92416
    v_add_lshl_u32 v226, v226, v225, 4
    v_lshrrev_b32 v225, 1, v227
    global_load_lds_dwordx4 v226, s[20:21]
    v_and_b32 v225, 4, v225
    v_and_or_b32 v225, v227, 2, v225
    s_add_u32 m0, s42, 108800
    v_xor_b32 v225, v225, v0
    v_lshlrev_b32 v60, 4, v225
    global_load_lds_dwordx4 v60, s[28:29]
    v_lshlrev_b32 v106, 2, v106
    v_lshlrev_b32 v107, 2, v107
    v_lshlrev_b32 v108, 2, v108
    v_lshlrev_b32 v109, 2, v109
    v_lshlrev_b32 v110, 2, v110
    v_lshlrev_b32 v111, 2, v111
    v_lshlrev_b32 v112, 2, v112
    v_lshlrev_b32 v113, 2, v113
    s_sub_u32 s6, 12500, s5
    s_min_u32 s6, s6, 49
    v_and_b32 v10, 0x70, v247
    s_lshr_b32 s44, s3, 1
    s_and_b32 s45, s3, 1
    s_lshl_b32 s45, s45, 6
    s_lshl_b32 s58, s44, 11
    s_add_u32 s59, s58, s45
    s_mul_i32 s60, s44, 16640
    s_add_u32 s60, s45, s60
    s_mul_i32 s61, s44, 2304
    s_lshl_b32 s44, s44, 4
    s_sub_i32 s62, s6, s44
    s_lshl_b32 s63, s62, 2
    v_cmp_gt_i32 s[40:41], s63, v25
    s_sub_i32 s63, 50, s44
    s_mov_b32 s90, 0xbfb8aa3b
    s_mov_b32 s91, s90
    s_lshl_b32 s44, s5, 7
    s_add_u32 s1, s44, s59
    s_waitcnt lgkmcnt(0)
    s_barrier
    ds_read_b128 v[210:213], v222 offset:9008
    ds_read_b128 v[180:183], v222 offset:31920
    ds_read_b128 v[166:169], v222 offset:32944
    s_mov_b32 s80, 24
    s_mov_b32 s81, 36
    s_mov_b32 s82, 36
    s_mov_b32 s46, 0x55555556
    s_waitcnt lgkmcnt(2)
    v_add3_u32 v219, v210, v211, v212
    v_add_u32 v220, v219, v213
    v_mov_b32 v221, v220
    v_mad_i32_i24 v106, v126, s47, v106
    v_mad_i32_i24 v107, v127, s47, v107
    v_add_u32_dpp v221, v221, v221 row_shr:1 row_mask:0xf bank_mask:0xf bound_ctrl:1
    v_mad_i32_i24 v108, v128, s47, v108
    v_mad_i32_i24 v109, v129, s47, v109
    v_add_u32_dpp v221, v221, v221 row_shr:2 row_mask:0xf bank_mask:0xf bound_ctrl:1
    v_mad_i32_i24 v110, v130, s47, v110
    v_mad_i32_i24 v111, v131, s47, v111
    v_add_u32_dpp v221, v221, v221 row_shr:4 row_mask:0xf bank_mask:0xf bound_ctrl:1
    v_mad_i32_i24 v112, v132, s47, v112
    v_mad_i32_i24 v113, v133, s47, v113
    v_add_u32_dpp v221, v221, v221 row_shr:8 row_mask:0xf bank_mask:0xf bound_ctrl:1
    v_and_b32 v19, 0x30, v247
    v_and_b32 v21, 0x30, v247
    v_add_u32_dpp v221, v221, v221 row_bcast:15 row_mask:0xa bank_mask:0xf
    s_mov_b32 s47, 0x2aaaaaab
    s_nop 0
    v_add_u32_dpp v221, v221, v221 row_bcast:31 row_mask:0xc bank_mask:0xf
    v_sub_u32 v214, v221, v220
    v_add_u32 v215, v214, v210
    v_add_u32 v216, v215, v211
    v_add_u32 v217, v214, v219
    ds_write_b128 v222, v[214:217] offset:10032
    s_mov_b64 exec, s[36:37]
    ds_read_b32 v146, v126 offset:10032
    ds_read_b32 v147, v127 offset:10032
    ds_read_b32 v148, v128 offset:10032
    ds_read_b32 v149, v129 offset:10032
    s_mov_b64 exec, s[38:39]
    ds_read_b32 v150, v130 offset:10032
    ds_read_b32 v151, v131 offset:10032
    ds_read_b32 v152, v132 offset:10032
    ds_read_b32 v153, v133 offset:10032
    s_cmp_eq_u32 s3, 0
    s_cselect_b64 exec, -1, 0
    global_load_dword v155, v253, s[34:35] sc1
    s_mov_b64 exec, -1
    s_add_u32 s48, s28, 8192
    s_addc_u32 s49, s29, 0
    s_add_u32 m0, s42, 116992
    s_add_u32 s52, s28, 16384
    global_load_lds_dwordx4 v60, s[48:49]
    s_addc_u32 s53, s29, 0
    s_mov_b32 m0, 8880
    s_mov_b32 exec_hi, 0
    global_load_lds_dword v252, s[52:53]
    s_mov_b32 s88, 0
    s_mov_b64 exec, s[36:37]
    s_waitcnt lgkmcnt(4)
    v_add_u32 v146, v146, v138
    v_add_u32 v147, v147, v139
    v_add_u32 v148, v148, v140
    v_add_u32 v149, v149, v141
    v_mul_hi_u32 v138, v146, s46
    v_mul_hi_u32 v139, v147, s46
    v_mul_hi_u32 v140, v148, s46
    v_mul_hi_u32 v141, v149, s46
    v_add_u32 v126, v138, v146
    ds_write_b8 v126, v106 offset:36016
    v_add_u32 v127, v139, v147
    ds_write_b8 v127, v107 offset:36016
    v_add_u32 v128, v140, v148
    ds_write_b8 v128, v108 offset:36016
    v_add_u32 v129, v141, v149
    ds_write_b8 v129, v109 offset:36016
    s_mov_b64 exec, s[38:39]
    s_waitcnt lgkmcnt(4)
    v_add_u32 v150, v150, v142
    v_add_u32 v151, v151, v143
    v_add_u32 v152, v152, v144
    v_add_u32 v153, v153, v145
    v_mul_hi_u32 v142, v150, s46
    v_mul_hi_u32 v143, v151, s46
    v_mul_hi_u32 v144, v152, s46
    v_mul_hi_u32 v145, v153, s46
    v_add_u32 v130, v142, v150
    ds_write_b8 v130, v110 offset:36016
    v_add_u32 v131, v143, v151
    ds_write_b8 v131, v111 offset:36016
    v_add_u32 v132, v144, v152
    ds_write_b8 v132, v112 offset:36016
    v_add_u32 v133, v145, v153
    ds_write_b8 v133, v113 offset:36016
    s_mov_b64 exec, -1
    v_lshlrev_b32 v146, 2, v126
    v_lshlrev_b32 v147, 2, v127
    v_lshlrev_b32 v148, 2, v128
    v_lshlrev_b32 v149, 2, v129
    v_lshlrev_b32 v150, 2, v130
    v_lshlrev_b32 v151, 2, v131
    v_lshlrev_b32 v152, 2, v132
    v_lshlrev_b32 v153, 2, v133
    s_cmp_lg_u32 s3, 0
    s_cbranch_scc1 L_NOPC
    v_mul_hi_u32 v154, v214, s47
    v_mul_hi_u32 v156, v215, s47
    v_mul_hi_u32 v158, v216, s47
    v_mul_hi_u32 v160, v217, s47
    v_mad_i32_i24 v214, v154, -6, v214
    v_mad_i32_i24 v215, v156, -6, v215
    v_mad_i32_i24 v216, v158, -6, v216
    v_mad_i32_i24 v217, v160, -6, v217
    v_mul_u32_u24 v214, 9, v214
    v_mul_u32_u24 v215, 9, v215
    v_mul_u32_u24 v216, 9, v216
    v_mul_u32_u24 v217, 9, v217
    v_lshl_add_u32 v214, v210, 3, v214
    v_lshl_add_u32 v215, v211, 3, v215
    v_lshl_add_u32 v216, v212, 3, v216
    v_lshl_add_u32 v217, v213, 3, v217
    v_lshl_add_u32 v214, v214, 11, v154
    v_lshl_add_u32 v215, v215, 11, v156
    v_lshl_add_u32 v216, v216, 11, v158
    v_lshl_add_u32 v217, v217, 11, v160
    v_lshlrev_b32 v154, 5, v214
    v_lshlrev_b32 v156, 5, v215
    v_lshlrev_b32 v158, 5, v216
    v_lshlrev_b32 v160, 5, v217
L_NOPC:
    s_mov_b32 s46, 0xffff0000
    s_mov_b64 exec, s[38:39]
    s_waitcnt vmcnt(9)
    v_lshl_or_b32 v118, v124, 16, v118
    ds_write_b32 v150, v118 offset:11056
    v_and_or_b32 v119, v124, s46, v119
    ds_write_b32 v151, v119 offset:11056
    v_lshl_or_b32 v120, v125, 16, v120
    ds_write_b32 v152, v120 offset:11056
    v_and_or_b32 v121, v125, s46, v121
    ds_write_b32 v153, v121 offset:11056
    s_mov_b64 exec, s[36:37]
    s_waitcnt vmcnt(7)
    v_lshl_or_b32 v114, v122, 16, v114
    ds_write_b32 v146, v114 offset:11056
    v_and_or_b32 v115, v122, s46, v115
    ds_write_b32 v147, v115 offset:11056
    v_lshl_or_b32 v116, v123, 16, v116
    ds_write_b32 v148, v116 offset:11056
    v_and_or_b32 v117, v123, s46, v117
    ds_write_b32 v149, v117 offset:11056
    s_mov_b64 exec, -1
    v_lshlrev_b32 v219, 2, v0
    v_add_u32 v219, 36016, v219
    v_lshrrev_b32 v220, 2, v178
    s_cmp_lg_u32 s3, 0
    s_waitcnt vmcnt(0)
    s_cbranch_scc1 L_PUBD
L_PUB:
    v_cmp_eq_u32 vcc, 0, v155
    s_cbranch_vccnz L_NONCEW
    ds_write_b32 v253, v155 offset:8864
    v_mov_b32 v157, v155
    v_mov_b32 v159, v155
    v_mov_b32 v161, v155
    buffer_store_dwordx4 v[154:157], v247, s[8:11], s57 offen sc1
    buffer_store_dwordx4 v[158:161], v247, s[8:11], s57 offen offset:1024 sc1
L_PUBD:
    s_waitcnt lgkmcnt(0)
    s_barrier
    ds_read_b32 v223, v253 offset:8864
    ds_read_b128 v[240:243], v222 offset:34992
    ds_read2st64_b32 v[118:119], v219 offset0:0 offset1:8
    ds_read_b128 v[106:109], v247 offset:11056
    ds_read_b128 v[110:113], v247 offset:19248
    ds_read_b32 v120, v220 offset:36016
    ds_read_b128 v[114:117], v178 offset:11056
    s_mov_b32 s46, 0xfcfcfc
    s_waitcnt lgkmcnt(5)
    v_mul_lo_u32 v243, v243, v223
    v_readfirstlane_b32 s89, v223
    v_and_b32 v243, 0xff030303, v243
    s_waitcnt lgkmcnt(3)
    v_and_or_b32 v109, v118, s46, v243
    buffer_store_dwordx4 v[106:109], v247, s[8:11], s43 offen sc1
    s_waitcnt lgkmcnt(2)
    v_and_or_b32 v113, v119, s46, v243
    buffer_store_dwordx4 v[110:113], v247, s[8:11], s55 offen sc1
    s_mov_b32 exec_lo, s56
    s_mov_b32 exec_hi, 0
    s_waitcnt lgkmcnt(0)
    v_and_or_b32 v117, v120, s46, v243
    buffer_store_dwordx4 v[114:117], v178, s[8:11], s43 offen sc1
    s_mov_b64 exec, -1
    v_add_u32 v170, s58, v180
    v_xor_b32 v171, 64, v170
    v_xor_b32 v172, s45, v181
    v_xor_b32 v173, 32, v172
    ds_read_b128 v[186:189], v170
    ds_read_b128 v[190:193], v171
    ds_read_b64_tr_b16 v[194:195], v172 offset:0
    ds_read_b64_tr_b16 v[196:197], v172 offset:512
    ds_read_b64_tr_b16 v[198:199], v172 offset:4096
    ds_read_b64_tr_b16 v[200:201], v172 offset:4608
    ds_read_b64_tr_b16 v[202:203], v173 offset:0
    ds_read_b64_tr_b16 v[204:205], v173 offset:512
    ds_read_b64_tr_b16 v[206:207], v173 offset:4096
    ds_read_b64_tr_b16 v[208:209], v173 offset:4608
    v_xor_b32 v176, s45, v170
    v_add_u32 v167, s58, v167
    v_xor_b32 v167, s45, v167
    v_add_u32 v168, s60, v168
    v_add_u32 v246, s61, v169
    v_xor_b32 v174, s45, v182
    v_xor_b32 v175, 32, v174
    s_lshr_b32 s47, s4, 2
    s_lshl_b32 s47, s47, 1
    s_and_b32 s46, s4, 1
    s_add_u32 s47, s47, s46
    s_and_b32 s46, s4, 2
    s_lshl_b32 s46, s46, 6
    s_add_u32 s47, s47, s46
    s_lshl_b32 s47, s47, 3
    s_add_u32 s47, s47, 0x190000
    v_mul_lo_u32 v241, v241, v223
    v_and_b32 v241, 0xff030303, v241
    v_and_b32 v226, 3, v0
    v_lshl_add_u32 v226, v227, 2, v226
    v_lshl_add_u32 v249, v226, 11, s47
    s_movk_i32 s46, 16768
    v_and_b32 v225, 16, v252
    v_mad_u32_u24 v251, v226, s46, v225
    s_mov_b32 s46, 67072
    v_mad_u32_u24 v250, v227, s46, v10
    v_and_b32 v248, 6, v0
    v_mad_u32_u24 v248, v248, 24, 7
    s_cmpk_eq_u32 s2, 255
    s_cselect_b32 exec_lo, -1, 0
    s_mov_b32 exec_hi, 0
    s_mov_b32 s44, 1600000
    buffer_store_dword v253, v252, s[8:11], s44 offen sc1
    s_mov_b64 exec, -1
    s_waitcnt lgkmcnt(0)
    v_mfma_f32_16x16x32_bf16 v[82:85], v[194:197], v[186:189], 0
    v_mfma_f32_16x16x32_bf16 v[86:89], v[202:205], v[186:189], 0
    v_mfma_f32_16x16x32_bf16 v[82:85], v[198:201], v[190:193], v[82:85]
    v_mfma_f32_16x16x32_bf16 v[86:89], v[206:209], v[190:193], v[86:89]
    ds_read_b64_tr_b16 v[138:139], v172 offset:8192
    ds_read_b64_tr_b16 v[140:141], v172 offset:8704
    ds_read_b64_tr_b16 v[142:143], v172 offset:12288
    ds_read_b64_tr_b16 v[144:145], v172 offset:12800
    ds_read_b64_tr_b16 v[146:147], v173 offset:8192
    ds_read_b64_tr_b16 v[148:149], v173 offset:8704
    ds_read_b64_tr_b16 v[150:151], v173 offset:12288
    ds_read_b64_tr_b16 v[152:153], v173 offset:12800
    v_pk_mul_f32 v[82:83], v[82:83], s[90:91]
    v_pk_mul_f32 v[84:85], v[84:85], s[90:91]
    v_pk_mul_f32 v[86:87], v[86:87], s[90:91]
    v_pk_mul_f32 v[88:89], v[88:89], s[90:91]
    v_cvt_pk_bf16_f32 v90, v82, v83
    v_cvt_pk_bf16_f32 v91, v84, v85
    v_cvt_pk_bf16_f32 v92, v86, v87
    v_cvt_pk_bf16_f32 v93, v88, v89
    ds_write_b128 v176, v[90:93] offset:8192
    ds_read_b128 v[94:97], v167
    s_waitcnt lgkmcnt(2)
    v_mfma_f32_16x16x32_bf16 v[122:125], v[138:141], v[186:189], 0
    v_mfma_f32_16x16x32_bf16 v[126:129], v[146:149], v[186:189], 0
    v_mfma_f32_16x16x32_bf16 v[122:125], v[142:145], v[190:193], v[122:125]
    v_mfma_f32_16x16x32_bf16 v[126:129], v[150:153], v[190:193], v[126:129]
    s_waitcnt lgkmcnt(0)
    s_mov_b64 exec, s[40:41]
    buffer_store_dwordx4 v[94:97], v166, s[8:11], s1 offen sc1
    s_mov_b64 exec, -1
    ds_read_b128 v[50:53], v222 offset:27824
    ds_read_b128 v[54:57], v222 offset:28848
    ds_read_b128 v[236:239], v222 offset:33968
    s_add_u32 m0, s42, 125184
    s_add_u32 s50, s30, 8192
    s_addc_u32 s51, s31, 0
    global_load_lds_dwordx4 v60, s[30:31]
    s_add_u32 m0, m0, 8192
    s_nop 0
    global_load_lds_dwordx4 v60, s[50:51]
    v_mov_b64 v[130:131], 0
    v_mov_b64 v[132:133], 0
    ds_read_u16_d16_hi v130, v183 offset:8880
    ds_read_u16_d16_hi v131, v183 offset:8888
    ds_read_u16_d16_hi v132, v183 offset:8896
    ds_read_u16_d16_hi v133, v183 offset:8904
    v_and_b32 v225, 15, v0
    v_cmp_gt_i32 s[38:39], s62, v225
    v_pk_mul_f32 v[122:123], v[122:123], s[90:91]
    v_pk_mul_f32 v[124:125], v[124:125], s[90:91]
    v_pk_mul_f32 v[126:127], v[126:127], s[90:91]
    v_pk_mul_f32 v[128:129], v[128:129], s[90:91]
    v_exp_f32 v210, v122
    v_exp_f32 v211, v123
    v_exp_f32 v212, v124
    v_exp_f32 v213, v125
    v_exp_f32 v214, v126
    v_exp_f32 v215, v127
    v_exp_f32 v216, v128
    v_exp_f32 v217, v129
    v_pk_add_f32 v[210:211], v[210:211], 1.0 op_sel_hi:[1,0]
    v_pk_add_f32 v[212:213], v[212:213], 1.0 op_sel_hi:[1,0]
    v_pk_add_f32 v[214:215], v[214:215], 1.0 op_sel_hi:[1,0]
    v_pk_add_f32 v[216:217], v[216:217], 1.0 op_sel_hi:[1,0]
    v_rcp_f32 v210, v210
    v_rcp_f32 v211, v211
    v_rcp_f32 v212, v212
    v_rcp_f32 v213, v213
    v_rcp_f32 v214, v214
    v_rcp_f32 v215, v215
    v_rcp_f32 v216, v216
    v_rcp_f32 v217, v217
    v_pk_mul_f32 v[210:211], v[122:123], v[210:211]
    v_pk_mul_f32 v[212:213], v[124:125], v[212:213]
    v_pk_mul_f32 v[214:215], v[126:127], v[214:215]
    v_pk_mul_f32 v[216:217], v[128:129], v[216:217]
    v_cmpx_gt_i32 vcc, s63, v225
    ds_write_b128 v168, v[122:125]
    ds_write_b128 v168, v[126:129] offset:128
    ds_write_b128 v168, v[210:213] offset:256
    ds_write_b128 v168, v[214:217] offset:384
    s_mov_b64 exec, -1
    v_mov_b32 v111, s89
    s_mov_b32 exec_lo, 0x0f0f0f0f
    s_mov_b32 exec_hi, exec_lo
    buffer_load_dwordx2 v[110:111], v249, s[8:11], 0 offen sc1
    s_mov_b64 exec, -1
    s_mov_b32 s12, s8
    s_or_b32 s13, s9, 0x800000
    s_mov_b32 s14, 1600128
    s_mov_b32 s15, 0x20000
    s_mov_b32 s16, s32
    s_mov_b32 s17, s33
    s_mov_b32 s18, 1600000
    s_mov_b32 s19, 0x20000
    v_and_b32 v228, 0x1f0, v247
    s_lshl_b32 s44, s3, 9
    s_add_u32 s44, s44, 0x18c000
    v_add_u32 v228, s44, v228
    s_mul_i32 s44, s7, 392
    s_mul_i32 s45, s3, 49
    s_add_u32 s44, s44, s45
    v_add_lshl_u32 v229, v25, s44, 7
    v_mov_b64 v[26:27], 0
    v_mov_b64 v[28:29], 0
    v_mov_b64 v[2:3], 0
    v_mov_b64 v[4:5], 0
    v_mov_b64 v[6:7], 0
    v_mov_b64 v[8:9], 0
    s_movk_i32 s92, 128
    s_mov_b32 s93, 0xff000000
    s_mov_b32 s83, 0
    s_mov_b32 s0, 1
    v_mov_b32 v224, s89
    v_not_b32 v225, v224
    s_lshl_b32 s47, s2, 4
    s_add_u32 s47, s47, 0x18c000
    v_mov_b32 v141, v243
    v_mov_b32 v145, v243
    v_mov_b32 v149, v243
    v_mov_b32 v153, v243
    v_mov_b32 v157, v241
    v_mov_b32 v161, v241
    s_mov_b32 s46, 0x8000801f
    s_mov_b64 exec, 1
    s_waitcnt vmcnt(3)
    ds_add_rtn_u32 v218, v253, v218 offset:8868
    s_waitcnt lgkmcnt(0)
    v_cmpx_eq_u32 vcc, 7, v218
    buffer_store_dwordx2 v[224:225], off, s[8:11], s47 sc1
    s_mov_b64 exec, -1
    s_waitcnt vmcnt(1)
L_ENT:
    s_nop 1
    v_mov_b32_dpp v110, v110 row_shr:4 row_mask:0xf bank_mask:0xa
    v_xor_b32 v111, s89, v111
    v_and_or_b32 v111, v110, s46, v111
    v_cmp_ne_u32 vcc, 0, v111
    v_mov_b32_dpp v106, v110 quad_perm:[0,0,0,0] row_mask:0xf bank_mask:0xf
    v_mov_b32_dpp v107, v110 quad_perm:[1,1,1,1] row_mask:0xf bank_mask:0xf
    v_mov_b32_dpp v108, v110 quad_perm:[2,2,2,2] row_mask:0xf bank_mask:0xf
    v_mov_b32_dpp v109, v110 quad_perm:[3,3,3,3] row_mask:0xf bank_mask:0xf
    s_cbranch_vccnz L_ENTR
    s_mov_b32 s88, 0
L_LOADS:
    s_mov_b32 s46, 0x210000
    v_add_u32_sdwa v220, v106, v250 dst_sel:DWORD dst_unused:UNUSED_PAD src0_sel:WORD_0 src1_sel:DWORD
    v_cmpx_lt_u32_sdwa vcc, v248, v106 src0_sel:DWORD src1_sel:WORD_1
    buffer_load_dwordx4 v[138:141], v220, s[8:11], s46 offen sc1
    s_mov_b64 exec, -1
    s_add_u32 s46, s46, 16768
    v_add_u32_sdwa v220, v107, v250 dst_sel:DWORD dst_unused:UNUSED_PAD src0_sel:WORD_0 src1_sel:DWORD
    v_cmpx_lt_u32_sdwa vcc, v248, v107 src0_sel:DWORD src1_sel:WORD_1
    buffer_load_dwordx4 v[142:145], v220, s[8:11], s46 offen sc1
    s_mov_b64 exec, -1
    s_add_u32 s46, s46, 16768
    v_add_u32_sdwa v220, v108, v250 dst_sel:DWORD dst_unused:UNUSED_PAD src0_sel:WORD_0 src1_sel:DWORD
    v_cmpx_lt_u32_sdwa vcc, v248, v108 src0_sel:DWORD src1_sel:WORD_1
    buffer_load_dwordx4 v[146:149], v220, s[8:11], s46 offen sc1
    s_mov_b64 exec, -1
    s_add_u32 s46, s46, 16768
    v_add_u32_sdwa v220, v109, v250 dst_sel:DWORD dst_unused:UNUSED_PAD src0_sel:WORD_0 src1_sel:DWORD
    v_cmpx_lt_u32_sdwa vcc, v248, v109 src0_sel:DWORD src1_sel:WORD_1
    buffer_load_dwordx4 v[150:153], v220, s[8:11], s46 offen sc1
    s_mov_b64 exec, -1
    v_lshrrev_b32 v219, 19, v110
    s_mov_b32 s97, 0
    v_cmp_lt_u32 s[100:101], s82, v219
    v_cmpx_lt_u32 vcc, s80, v219
    s_cbranch_execz L_NOB
    s_mov_b32 s46, 0x210080
    v_add_u32_sdwa v220, v110, v251 dst_sel:DWORD dst_unused:UNUSED_PAD src0_sel:WORD_0 src1_sel:DWORD
    v_subrev_u32 v219, s80, v219
    buffer_load_dwordx4 v[154:157], v220, s[8:11], s46 offen sc1
    v_bfe_u32 v221, v0, 2, 1
    v_mad_i32_i24 v221, v221, -3, v219
    v_cmp_lt_i32 s[72:73], 0, v221
    v_cmp_lt_i32 s[74:75], 1, v221
    v_cmp_lt_i32 s[76:77], 2, v221
    v_cmp_lt_i32 s[78:79], 6, v221
    v_cmp_lt_i32 s[26:27], 7, v221
    v_cmp_lt_i32 s[28:29], 8, v221
    v_cmpx_lt_i32 vcc, 6, v219
    buffer_load_dwordx4 v[158:161], v220, s[8:11], s46 offen offset:32 sc1
    s_cmp_lg_u64 vcc, 0
    s_cselect_b32 s97, 2, 1
L_NOB:
    s_mov_b64 exec, -1
    v_bfe_u32 v219, v106, 16, 3
    v_lshrrev_b32 v220, 19, v106
    v_sub_u32 v221, v239, v219
    v_sub_u32 v220, v220, v219
    v_cmp_lt_u32 s[48:49], v221, v220
    v_add_u32 v221, 1, v221
    v_cmp_lt_u32 s[50:51], v221, v220
    v_add_u32 v221, 1, v221
    v_cmp_lt_u32 s[52:53], v221, v220
    v_bfe_u32 v219, v107, 16, 3
    v_lshrrev_b32 v220, 19, v107
    v_sub_u32 v221, v239, v219
    v_sub_u32 v220, v220, v219
    v_cmp_lt_u32 s[54:55], v221, v220
    v_add_u32 v221, 1, v221
    v_cmp_lt_u32 s[56:57], v221, v220
    v_add_u32 v221, 1, v221
    v_cmp_lt_u32 s[58:59], v221, v220
    v_bfe_u32 v219, v108, 16, 3
    v_lshrrev_b32 v220, 19, v108
    v_sub_u32 v221, v239, v219
    v_sub_u32 v220, v220, v219
    v_cmp_lt_u32 s[60:61], v221, v220
    v_add_u32 v221, 1, v221
    v_cmp_lt_u32 s[62:63], v221, v220
    v_add_u32 v221, 1, v221
    v_cmp_lt_u32 s[64:65], v221, v220
    v_bfe_u32 v219, v109, 16, 3
    v_lshrrev_b32 v220, 19, v109
    v_sub_u32 v221, v239, v219
    v_sub_u32 v220, v220, v219
    v_cmp_lt_u32 s[66:67], v221, v220
    v_add_u32 v221, 1, v221
    v_cmp_lt_u32 s[68:69], v221, v220
    v_add_u32 v221, 1, v221
    v_cmp_lt_u32 s[70:71], v221, v220
    s_cmp_lg_u32 s0, 1
    s_cbranch_scc1 L_HIST
    s_mov_b32 s0, 2
    v_pk_mul_f32 v[130:131], v[130:131], s[90:91]
    v_pk_mul_f32 v[132:133], v[132:133], s[90:91]
    v_cvt_pk_bf16_f32 v130, v130, v131
    v_cvt_pk_bf16_f32 v131, v132, v133
    v_and_b32 v58, v130, v55
    v_and_b32 v59, v131, v55
    s_bfm_b64 s[36:37], s6, 0
    s_lshl_b32 s44, s3, 4
    v_add_u32 v237, s44, v237
    v_add_u32 v245, s44, v238
    v_add_u32 v238, 0xffe00000, v238
    s_mul_i32 s44, s3, 2176
    v_add_u32 v244, s44, v242
    s_mov_b32 s20, 0x11111111
    s_mov_b32 s21, s20
    s_mov_b32 s30, 0x200000
    s_mov_b32 s40, 0x40000000
    s_mov_b32 s41, s40
L_HIST:
    v_mov_b64 v[186:187], s[40:41]
    v_mov_b64 v[188:189], s[40:41]
    v_mov_b64 v[190:191], s[40:41]
    v_mov_b64 v[192:193], s[40:41]
    v_mov_b64 v[194:195], s[40:41]
    v_mov_b64 v[196:197], s[40:41]
    v_mov_b64 v[198:199], s[40:41]
    v_mov_b64 v[200:201], s[40:41]
    v_mov_b64 v[202:203], s[40:41]
    v_mov_b32 v223, 4
    s_mov_b64 exec, s[100:101]
    ds_write_b32 v253, v223 offset:8592
    s_mov_b64 exec, -1
    s_waitcnt vmcnt(0)
    v_xor_b32 v141, v141, v243
    v_xor_b32 v145, v145, v243
    v_xor_b32 v149, v149, v243
    v_xor_b32 v153, v153, v243
    v_xor_b32 v157, v157, v241
    v_xor_b32 v161, v161, v241
    v_or3_b32 v221, v141, v145, v149
    v_or3_b32 v220, v153, v157, v161
    v_or_b32 v221, v221, v220
    v_and_b32 v221, 0xff030303, v221
    v_cmp_ne_u32 vcc, 0, v221
    s_cbranch_vccnz L_HR
    s_mov_b32 exec_lo, 0xfff
    s_mov_b32 exec_hi, 0x0
    buffer_load_dword v254, v229, s[8:11], 0 offen sc1
    s_mov_b64 exec, -1
    s_cmp_eq_u32 s97, 2
    s_cbranch_scc1 L_RAREX
L_RAREXD:
    v_and_b32 v112, 0xff, v141
    v_bfe_u32 v113, v141, 8, 8
    v_lshrrev_b32 v141, 16, v141
    v_and_b32 v114, 0xff, v145
    v_bfe_u32 v115, v145, 8, 8
    v_lshrrev_b32 v145, 16, v145
    v_and_b32 v116, 0xff, v149
    v_bfe_u32 v117, v149, 8, 8
    v_lshrrev_b32 v149, 16, v149
    v_and_b32 v118, 0xff, v153
    v_bfe_u32 v119, v153, 8, 8
    v_lshrrev_b32 v153, 16, v153
    s_cmp_eq_u32 s97, 0
    s_cbranch_scc1 L_RARE1
    v_and_b32 v120, 0xff, v157
    v_bfe_u32 v121, v157, 8, 8
    v_lshrrev_b32 v157, 16, v157
    s_mov_b64 exec, s[72:73]
    ds_add_rtn_u32 v198, v120, v223 offset:8336
    s_mov_b64 exec, s[74:75]
    ds_add_rtn_u32 v199, v121, v223 offset:8336
    s_mov_b64 exec, s[76:77]
    ds_add_rtn_u32 v200, v157, v223 offset:8336
L_RARE1:
    s_mov_b64 exec, s[48:49]
    ds_add_rtn_u32 v186, v112, v223 offset:8336
    s_mov_b64 exec, s[50:51]
    ds_add_rtn_u32 v187, v113, v223 offset:8336
    s_mov_b64 exec, s[52:53]
    ds_add_rtn_u32 v188, v141, v223 offset:8336
    s_mov_b64 exec, s[54:55]
    ds_add_rtn_u32 v189, v114, v223 offset:8336
    s_mov_b64 exec, s[56:57]
    ds_add_rtn_u32 v190, v115, v223 offset:8336
    s_mov_b64 exec, s[58:59]
    ds_add_rtn_u32 v191, v145, v223 offset:8336
    s_mov_b64 exec, s[60:61]
    ds_add_rtn_u32 v192, v116, v223 offset:8336
    s_mov_b64 exec, s[62:63]
    ds_add_rtn_u32 v193, v117, v223 offset:8336
    s_mov_b64 exec, s[64:65]
    ds_add_rtn_u32 v194, v149, v223 offset:8336
    s_mov_b64 exec, s[66:67]
    ds_add_rtn_u32 v195, v118, v223 offset:8336
    s_mov_b64 exec, s[68:69]
    ds_add_rtn_u32 v196, v119, v223 offset:8336
    s_mov_b64 exec, s[70:71]
    ds_add_rtn_u32 v197, v153, v223 offset:8336
    s_mov_b64 exec, -1
    s_cbranch_scc1 L_RARE2
    s_waitcnt lgkmcnt(12)
    ds_write_b32 v198, v154
    ds_write_b32 v199, v155
    ds_write_b32 v200, v156
L_RARE2:
    s_waitcnt lgkmcnt(9)
    ds_write_b32 v186, v138
    ds_write_b32 v187, v139
    ds_write_b32 v188, v140
    s_waitcnt lgkmcnt(9)
    ds_write_b32 v189, v142
    ds_write_b32 v190, v143
    ds_write_b32 v191, v144
    s_waitcnt lgkmcnt(9)
    ds_write_b32 v192, v146
    ds_write_b32 v193, v147
    ds_write_b32 v194, v148
    s_waitcnt lgkmcnt(9)
    ds_write_b32 v195, v150
    ds_write_b32 v196, v151
    ds_write_b32 v197, v152
    s_cmp_lg_u32 s83, 0
    s_cselect_b32 s44, 1.0, 0x1f800000
    s_mov_b32 s45, s44
    s_lshl_b32 s46, s3, 4
    s_waitcnt lgkmcnt(0)
    s_barrier
    ds_read_b32 v224, v252 offset:8336
    buffer_load_dwordx2 v[16:17], v228, s[8:11], 0 offen sc1
    s_mov_b32 exec_lo, 0xfff000
    s_mov_b32 exec_hi, 0x0
    buffer_load_dword v254, v229, s[8:11], 0 offen sc1
    s_mov_b64 exec, -1
    v_mov_b32 v64, v63
    s_waitcnt lgkmcnt(0)
    v_sub_u32 v224, v224, v63
    v_add_u32 v225, 12, v224
    v_and_b32 v225, -16, v225
    v_max_u32 v225, 16, v225
    v_cndmask_b32 v225, 0, v225, s[36:37]
    v_mov_b32 v226, v225
    v_sub_u32 v218, v225, v224
    v_cmp_lt_u32 vcc, 448, v224
    v_add_u32_dpp v226, v226, v226 row_shr:1 row_mask:0xf bank_mask:0xf bound_ctrl:1
    v_mov_b64 v[66:67], 0
    v_mov_b64 v[68:69], 0
    v_add_u32_dpp v226, v226, v226 row_shr:2 row_mask:0xf bank_mask:0xf bound_ctrl:1
    v_mov_b64 v[70:71], 0
    v_mov_b64 v[72:73], 0
    v_add_u32_dpp v226, v226, v226 row_shr:4 row_mask:0xf bank_mask:0xf bound_ctrl:1
    v_mov_b64 v[74:75], s[44:45]
    v_mov_b64 v[76:77], s[44:45]
    v_add_u32_dpp v226, v226, v226 row_shr:8 row_mask:0xf bank_mask:0xf bound_ctrl:1
    v_mov_b64 v[78:79], s[44:45]
    v_mov_b64 v[80:81], s[44:45]
    v_add_u32_dpp v226, v226, v226 row_bcast:15 row_mask:0xa bank_mask:0xf
    v_cvt_f32_u32 v24, v218
    v_mul_f32 v24, 0xbe800000, v24
    v_add_u32_dpp v226, v226, v226 row_bcast:31 row_mask:0xc bank_mask:0xf
    v_sub_u32 v227, v226, v225
    v_readlane_b32 s44, v226, 63
    s_mov_b32 s85, 0
    s_lshl_b32 s47, s3, 2
    s_cmpk_gt_u32 s44, 16384
    s_cbranch_scc1 L_TOOBIG
    s_cbranch_vccnz L_DENSE
L_DENSED:
    v_add_u32 v220, s46, v64
    v_subrev_u32 v221, s46, v225
    v_add_u32 v222, s46, v227
    v_lshl_add_u32 v221, v221, 17, v238
    v_lshrrev_b32 v222, 1, v222
L_QD:
    v_cmpx_lt_u32 vcc, s46, v225
    s_add_u32 s46, s46, 128
    ds_write_b64 v222, v[220:221] offset:0
    v_lshl_add_u64 v[220:221], v[220:221], 0, s[92:93]
    v_cmpx_lt_u32 vcc, s46, v225
    s_add_u32 s46, s46, 128
    ds_write_b64 v222, v[220:221] offset:64
    v_lshl_add_u64 v[220:221], v[220:221], 0, s[92:93]
    v_cmpx_lt_u32 vcc, s46, v225
    s_add_u32 s46, s46, 128
    ds_write_b64 v222, v[220:221] offset:128
    v_lshl_add_u64 v[220:221], v[220:221], 0, s[92:93]
    v_cmpx_lt_u32 vcc, s46, v225
    v_add_u32 v222, 192, v222
    s_cbranch_execnz L_QD
    s_mov_b64 exec, -1
    v_add3_u32 v219, v64, v224, s47
    v_cmpx_lt_u32 vcc, s47, v218
    ds_write_b32 v219, v62
    s_cmp_lg_u32 s3, 7
    s_cbranch_scc1 L_NOTL
    s_mov_b64 exec, 0xffff
    s_lshr_b32 s47, s44, 1
    v_lshl_add_u32 v219, v252, 1, s47
    v_mov_b32 v22, 8320
    v_mov_b32 v23, 0x40016420
    ds_write_b64 v219, v[22:23] offset:0
L_NOTL:
    s_mov_b64 exec, -1
    s_add_u32 s44, s44, 127
    s_lshr_b32 s94, s44, 10
    s_bfe_u32 s95, s44, 0x30007
    s_mul_i32 s44, s94, s3
    s_min_u32 s47, s95, s3
    s_add_u32 s86, s44, s47
    s_cmp_lt_u32 s3, s95
    s_addc_u32 s84, s94, 0
    s_lshl_b32 s44, s84, 3
    s_lshl_b32 s45, s86, 6
    v_mul_u32_u24 v61, s44, v240
    v_add_u32 v61, s45, v61
L_MAIN:
    s_waitcnt lgkmcnt(0)
    s_barrier
    ds_read2_b32 v[30:31], v61 offset0:0 offset1:2
    ds_read2_b32 v[22:23], v61 offset0:4 offset1:1
    v_mov_b32 v33, v19
    v_mov_b32 v233, v19
    s_waitcnt lgkmcnt(1)
    v_add_u32 v30, v30, v56
    v_add_u32 v14, v31, v56
    ds_read_u16 v18, v30 offset:0
    ds_read_u16 v20, v30 offset:8
    ds_read_u16 v32, v14
    ds_read_u16 v232, v14 offset:8
    s_waitcnt lgkmcnt(4)
    v_lshl_add_u64 v[12:13], v[22:23], 0, v[56:57]
    v_and_b32 v22, 0x1fffff, v13
    s_cmp_lg_u32 s85, 0
    s_cbranch_scc1 L_NOFC
    s_not_b32 s45, s89
    s_waitcnt vmcnt(1)
L_FC:
    v_xor_b32 v16, s89, v16
    v_xor_b32 v17, s45, v17
    v_or_b32 v16, v16, v17
    v_cmp_ne_u32 vcc, 0, v16
    s_cbranch_vccnz L_FR
L_NOFC:
    s_waitcnt lgkmcnt(0)
    s_barrier
    s_setprio 2
    buffer_load_dwordx4 v[106:109], v[18:19], s[12:15], 0 idxen offen offset:0
    buffer_load_dwordx4 v[114:117], v[20:21], s[12:15], 0 idxen offen offset:0
    buffer_load_dwordx4 v[110:113], v[18:19], s[12:15], 0 idxen offen offset:64
    buffer_load_dwordx4 v[118:121], v[20:21], s[12:15], 0 idxen offen offset:64
    ds_read_b128 v[34:37], v22 offset:0
    ds_read_b128 v[38:41], v22 offset:128
    s_mov_b64 exec, s[20:21]
    ds_read_u16 v26, v30 offset:2
    ds_read_u16 v28, v30 offset:10
    s_lshl_b64 exec, exec, 1
    ds_read_u16_d16_hi v26, v30 offset:2
    ds_read_u16_d16_hi v28, v30 offset:10
    s_lshl_b64 exec, exec, 1
    ds_read_u16 v27, v30 offset:2
    ds_read_u16 v29, v30 offset:10
    s_lshl_b64 exec, exec, 1
    ds_read_u16_d16_hi v27, v30 offset:2
    ds_read_u16_d16_hi v29, v30 offset:10
    s_mov_b64 exec, -1
    s_cmp_lg_u32 s85, 0
    s_cbranch_scc1 L_NOSH
    ds_read_b128 v[154:157], v245 offset:256
    ds_read_b128 v[158:161], v245 offset:384
    s_add_u32 s44, s94, 1
    v_cvt_f32_u32 v218, s44
    v_cvt_f32_u32 v219, s94
    v_lshrrev_b32 v220, 4, v226
    v_rcp_f32 v218, v218
    v_rcp_f32 v219, v219
    s_lshl_b32 s45, s95, 3
    s_mul_i32 s44, s44, s45
    v_cvt_f32_u32 v221, v220
    v_cmp_ge_u32 vcc, s44, v220
    v_subrev_u32 v220, s44, v220
    v_cvt_f32_i32 v220, v220
    v_add_f32 v221, -0.5, v221
    v_add_f32 v220, -0.5, v220
    v_mul_f32 v221, v221, v218
    v_mul_f32 v220, v220, v219
    v_cvt_u32_f32 v221, v221
    v_cvt_u32_f32 v220, v220
    v_add_u32 v220, s45, v220
    v_cndmask_b32 v221, v220, v221, vcc
    v_mul_u32_u24 v221, 272, v221
    s_lshl_b32 s46, s3, 4
    v_mov_b32 v218, 0x40000000
    v_mov_b32_dpp v222, v221 wave_shr:1 row_mask:0xf bank_mask:0xf bound_ctrl:1
    v_sub_u32 v221, v221, v222
    v_add_u32 v1, s46, v222
    v_cmp_lt_i32 s[44:45], 0, v221
    v_cmp_lt_i32 vcc, 272, v221
    s_nop 0
    v_cndmask_b32 v222, v218, v1, s[44:45]
    v_cndmask_b32 v223, v218, v1, vcc
    v_cmp_lt_i32 vcc, 544, v221
    s_waitcnt lgkmcnt(0)
    v_pk_fma_f32 v[2:3], v[154:155], v[24:25], v[2:3] op_sel_hi:[1,0,1]
    v_pk_fma_f32 v[4:5], v[156:157], v[24:25], v[4:5] op_sel_hi:[1,0,1]
    v_pk_fma_f32 v[6:7], v[158:159], v[24:25], v[6:7] op_sel_hi:[1,0,1]
    v_pk_fma_f32 v[8:9], v[160:161], v[24:25], v[8:9] op_sel_hi:[1,0,1]
    s_cmp_lg_u64 vcc, 0
    s_cselect_b32 s96, 1, 0
    s_cmp_lg_u32 s0, 2
    s_cbranch_scc1 L_NOSH
    s_mov_b32 s0, 0
    ds_read_b128 v[186:189], v170
    ds_read_b128 v[190:193], v171
    ds_read_b64_tr_b16 v[194:195], v172 offset:16384
    ds_read_b64_tr_b16 v[196:197], v172 offset:16896
    ds_read_b64_tr_b16 v[198:199], v172 offset:20480
    ds_read_b64_tr_b16 v[200:201], v172 offset:20992
    ds_read_b64_tr_b16 v[202:203], v173 offset:16384
    ds_read_b64_tr_b16 v[204:205], v173 offset:16896
    ds_read_b64_tr_b16 v[206:207], v173 offset:20480
    ds_read_b64_tr_b16 v[208:209], v173 offset:20992
    ds_read_b64_tr_b16 v[90:91], v174 offset:0
    ds_read_b64_tr_b16 v[92:93], v174 offset:2048
    ds_read_b64_tr_b16 v[94:95], v174 offset:4096
    ds_read_b64_tr_b16 v[96:97], v174 offset:6144
    ds_read_b64_tr_b16 v[98:99], v175 offset:0
    ds_read_b64_tr_b16 v[100:101], v175 offset:2048
    ds_read_b64_tr_b16 v[102:103], v175 offset:4096
    ds_read_b64_tr_b16 v[104:105], v175 offset:6144
    s_waitcnt lgkmcnt(8)
    v_mfma_f32_16x16x32_bf16 v[82:85], v[194:197], v[186:189], 0
    v_mfma_f32_16x16x32_bf16 v[86:89], v[202:205], v[186:189], 0
    v_mfma_f32_16x16x32_bf16 v[82:85], v[198:201], v[190:193], v[82:85]
    v_mfma_f32_16x16x32_bf16 v[86:89], v[206:209], v[190:193], v[86:89]
L_NOSH:
    buffer_load_dwordx4 v[122:125], v[32:33], s[12:15], 0 idxen offen offset:0
    buffer_load_dwordx4 v[130:133], v[232:233], s[12:15], 0 idxen offen offset:0
    buffer_load_dwordx4 v[126:129], v[32:33], s[12:15], 0 idxen offen offset:64
    buffer_load_dwordx4 v[134:137], v[232:233], s[12:15], 0 idxen offen offset:64
    s_sub_u32 s88, s84, 1
    s_cbranch_scc1 L_WEND
    s_waitcnt lgkmcnt(0)
    v_mov_b64 v[42:43], v[34:35]
    v_mov_b64 v[44:45], v[36:37]
    v_mov_b64 v[46:47], v[38:39]
    v_mov_b64 v[48:49], v[40:41]
    v_cmp_gt_u32 vcc, s30, v13
    s_mov_b64 s[24:25], 0
    v_mfma_f32_32x32x8_bf16 v[138:153], v[58:59], v[26:27], v[34:49]
    s_waitcnt vmcnt(4)
    s_cmp_lg_u32 s83, 0
    v_smfmac_f32_32x32x32_bf16 v[138:153], v[50:53], v[106:113], v54
    s_setprio 1
    s_nop 9
    s_cbranch_scc1 L_INS
    s_branch L_INF
.p2align 6
L_LOOPF:
    s_setprio 0
    ds_read_u16 v18, v12 offset:0
    ds_read_u16 v20, v12 offset:8
    s_cbranch_vccz L_CF0
    s_mov_b64 exec, vcc
    ds_read_b128 v[34:37], v13 offset:1040
    ds_read_b128 v[38:41], v13 offset:1168
    ds_read_b128 v[42:45], v13 offset:1040
    ds_read_b128 v[46:49], v13 offset:1168
L_CF0:
    s_mov_b64 exec, s[20:21]
    ds_read_u16 v26, v14 offset:2
    ds_read_u16 v28, v14 offset:10
    s_lshl_b64 exec, exec, 1
    ds_read_u16_d16_hi v26, v14 offset:2
    ds_read_u16_d16_hi v28, v14 offset:10
    s_lshl_b64 exec, exec, 1
    ds_read_u16 v27, v14 offset:2
    ds_read_u16 v29, v14 offset:10
    s_lshl_b64 exec, exec, 1
    ds_read_u16_d16_hi v27, v14 offset:2
    ds_read_u16_d16_hi v29, v14 offset:10
    s_mov_b64 exec, -1
    ds_read2_b32 v[22:23], v61 offset0:6 offset1:3
    s_cmp_lt_u32 s88, 2
    s_cbranch_scc1 L_GSF0
    s_waitcnt lgkmcnt(9)
    buffer_load_dwordx4 v[106:109], v[18:19], s[12:15], 0 idxen offen offset:0
    buffer_load_dwordx4 v[114:117], v[20:21], s[12:15], 0 idxen offen offset:0
    buffer_load_dwordx4 v[110:113], v[18:19], s[12:15], 0 idxen offen offset:64
    buffer_load_dwordx4 v[118:121], v[20:21], s[12:15], 0 idxen offen offset:64
L_GF0:
    s_cmp_eq_u64 s[24:25], 0
    s_cbranch_scc1 L_FSF0
    ds_write_b128 v15, v[66:69] offset:512
    ds_write_b128 v15, v[70:73] offset:640
    ds_write_b128 v15, v[74:77] offset:768
    ds_write_b128 v15, v[78:81] offset:896
L_FF0:
    s_mov_b64 s[24:25], vcc
    s_sub_u32 s88, s88, 1
    s_waitcnt vmcnt(4) lgkmcnt(4)
    v_pk_fma_f32 v[66:67], v[66:67], v[170:171], v[66:67]
    v_pk_fma_f32 v[68:69], v[68:69], v[172:173], v[68:69]
    v_pk_fma_f32 v[70:71], v[70:71], v[174:175], v[70:71]
    v_pk_fma_f32 v[72:73], v[72:73], v[176:177], v[72:73]
    v_pk_fma_f32 v[66:67], v[138:139], v[74:75], v[66:67]
    v_pk_fma_f32 v[68:69], v[140:141], v[76:77], v[68:69]
    v_pk_fma_f32 v[70:71], v[142:143], v[78:79], v[70:71]
    v_pk_fma_f32 v[72:73], v[144:145], v[80:81], v[72:73]
    v_pk_fma_f32 v[74:75], v[74:75], v[170:171], v[74:75]
    v_pk_fma_f32 v[76:77], v[76:77], v[172:173], v[76:77]
    v_pk_fma_f32 v[78:79], v[78:79], v[174:175], v[78:79]
    v_pk_fma_f32 v[80:81], v[80:81], v[176:177], v[80:81]
    v_pk_fma_f32 v[66:67], v[66:67], v[178:179], v[66:67]
    v_pk_fma_f32 v[68:69], v[68:69], v[180:181], v[68:69]
    v_pk_fma_f32 v[70:71], v[70:71], v[182:183], v[70:71]
    v_pk_fma_f32 v[72:73], v[72:73], v[184:185], v[72:73]
    v_pk_fma_f32 v[66:67], v[146:147], v[74:75], v[66:67]
    v_pk_fma_f32 v[68:69], v[148:149], v[76:77], v[68:69]
    v_pk_fma_f32 v[70:71], v[150:151], v[78:79], v[70:71]
    v_pk_fma_f32 v[72:73], v[152:153], v[80:81], v[72:73]
    v_pk_fma_f32 v[74:75], v[74:75], v[178:179], v[74:75]
    v_pk_fma_f32 v[76:77], v[76:77], v[180:181], v[76:77]
    v_pk_fma_f32 v[78:79], v[78:79], v[182:183], v[78:79]
    v_pk_fma_f32 v[80:81], v[80:81], v[184:185], v[80:81]
    s_setprio 1
    v_exp_f32 v170, v154
    v_mfma_f32_32x32x8_bf16 v[138:153], v[58:59], v[26:27], v[34:49]
    v_exp_f32 v171, v155
    v_exp_f32 v172, v156
    v_exp_f32 v173, v157
    v_exp_f32 v174, v158
    v_smfmac_f32_32x32x32_bf16 v[138:153], v[50:53], v[122:129], v54
    v_exp_f32 v175, v159
    v_exp_f32 v176, v160
    v_exp_f32 v177, v161
    v_exp_f32 v178, v162
    v_exp_f32 v179, v163
    v_exp_f32 v180, v164
    v_exp_f32 v181, v165
    v_exp_f32 v182, v166
    v_exp_f32 v183, v167
    v_exp_f32 v184, v168
    v_exp_f32_e64 v185, v169
    v_pk_fma_f32 v[66:67], v[66:67], v[170:171], v[66:67]
    v_pk_fma_f32 v[68:69], v[68:69], v[172:173], v[68:69]
    v_pk_fma_f32 v[70:71], v[70:71], v[174:175], v[70:71]
    v_pk_fma_f32 v[72:73], v[72:73], v[176:177], v[72:73]
    v_pk_fma_f32 v[66:67], v[154:155], v[74:75], v[66:67]
    v_pk_fma_f32 v[68:69], v[156:157], v[76:77], v[68:69]
    v_pk_fma_f32 v[70:71], v[158:159], v[78:79], v[70:71]
    v_pk_fma_f32 v[72:73], v[160:161], v[80:81], v[72:73]
    v_pk_fma_f32 v[74:75], v[74:75], v[170:171], v[74:75]
    v_pk_fma_f32 v[76:77], v[76:77], v[172:173], v[76:77]
    v_pk_fma_f32 v[78:79], v[78:79], v[174:175], v[78:79]
    v_pk_fma_f32 v[80:81], v[80:81], v[176:177], v[80:81]
    v_pk_fma_f32 v[66:67], v[66:67], v[178:179], v[66:67]
    v_pk_fma_f32 v[68:69], v[68:69], v[180:181], v[68:69]
    v_pk_fma_f32 v[70:71], v[70:71], v[182:183], v[70:71]
    v_pk_fma_f32 v[72:73], v[72:73], v[184:185], v[72:73]
    v_pk_fma_f32 v[66:67], v[162:163], v[74:75], v[66:67]
    v_pk_fma_f32 v[68:69], v[164:165], v[76:77], v[68:69]
    v_pk_fma_f32 v[70:71], v[166:167], v[78:79], v[70:71]
    v_pk_fma_f32 v[72:73], v[168:169], v[80:81], v[72:73]
    v_pk_fma_f32 v[74:75], v[74:75], v[178:179], v[74:75]
    v_pk_fma_f32 v[76:77], v[76:77], v[180:181], v[76:77]
    v_pk_fma_f32 v[78:79], v[78:79], v[182:183], v[78:79]
    v_pk_fma_f32 v[80:81], v[80:81], v[184:185], v[80:81]
    s_cbranch_scc1 L_XF0
    v_cmp_gt_u32 vcc, s30, v23
    v_lshl_add_u64 v[14:15], v[22:23], 0, v[56:57]
    v_exp_f32_e64 v170, v138
    v_mfma_f32_32x32x8_bf16 v[154:169], v[58:59], v[28:29], v[34:49]
    v_exp_f32 v171, v139
    v_exp_f32 v172, v140
    v_exp_f32 v173, v141
    v_exp_f32 v174, v142
    v_smfmac_f32_32x32x32_bf16 v[154:169], v[50:53], v[130:137], v54
    v_exp_f32 v175, v143
    v_exp_f32 v176, v144
    v_exp_f32 v177, v145
    v_exp_f32 v178, v146
    v_exp_f32 v179, v147
    v_exp_f32 v180, v148
    v_exp_f32 v181, v149
    v_exp_f32 v182, v150
    v_exp_f32 v183, v151
    v_exp_f32 v184, v152
    v_exp_f32 v185, v153
    s_setprio 0
    ds_read_u16 v18, v14 offset:0
    ds_read_u16 v20, v14 offset:8
    s_cbranch_vccz L_CF1
    s_mov_b64 exec, vcc
    ds_read_b128 v[34:37], v15 offset:1040
    ds_read_b128 v[38:41], v15 offset:1168
    ds_read_b128 v[42:45], v15 offset:1040
    ds_read_b128 v[46:49], v15 offset:1168
L_CF1:
    s_mov_b64 exec, s[20:21]
    ds_read_u16 v26, v12 offset:2
    ds_read_u16 v28, v12 offset:10
    s_lshl_b64 exec, exec, 1
    ds_read_u16_d16_hi v26, v12 offset:2
    ds_read_u16_d16_hi v28, v12 offset:10
    s_lshl_b64 exec, exec, 1
    ds_read_u16 v27, v12 offset:2
    ds_read_u16 v29, v12 offset:10
    s_lshl_b64 exec, exec, 1
    ds_read_u16_d16_hi v27, v12 offset:2
    ds_read_u16_d16_hi v29, v12 offset:10
    s_mov_b64 exec, -1
    ds_read2_b32 v[22:23], v61 offset0:8 offset1:5
    s_cmp_lt_u32 s88, 2
    s_cbranch_scc1 L_GSF1
    s_waitcnt lgkmcnt(9)
    buffer_load_dwordx4 v[122:125], v[18:19], s[12:15], 0 idxen offen offset:0
    buffer_load_dwordx4 v[130:133], v[20:21], s[12:15], 0 idxen offen offset:0
    buffer_load_dwordx4 v[126:129], v[18:19], s[12:15], 0 idxen offen offset:64
    buffer_load_dwordx4 v[134:137], v[20:21], s[12:15], 0 idxen offen offset:64
L_GF1:
    s_cmp_eq_u64 s[24:25], 0
    s_cbranch_scc1 L_FSF1
    ds_write_b128 v13, v[66:69] offset:512
    ds_write_b128 v13, v[70:73] offset:640
    ds_write_b128 v13, v[74:77] offset:768
    ds_write_b128 v13, v[78:81] offset:896
L_FF1:
    s_mov_b64 s[24:25], vcc
    s_sub_u32 s88, s88, 1
    s_waitcnt vmcnt(4) lgkmcnt(4)
    s_nop 0
    v_pk_fma_f32 v[66:67], v[66:67], v[170:171], v[66:67]
    v_pk_fma_f32 v[68:69], v[68:69], v[172:173], v[68:69]
    v_pk_fma_f32 v[70:71], v[70:71], v[174:175], v[70:71]
    v_pk_fma_f32 v[72:73], v[72:73], v[176:177], v[72:73]
    v_pk_fma_f32 v[66:67], v[138:139], v[74:75], v[66:67]
    v_pk_fma_f32 v[68:69], v[140:141], v[76:77], v[68:69]
    v_pk_fma_f32 v[70:71], v[142:143], v[78:79], v[70:71]
    v_pk_fma_f32 v[72:73], v[144:145], v[80:81], v[72:73]
    v_pk_fma_f32 v[74:75], v[74:75], v[170:171], v[74:75]
    v_pk_fma_f32 v[76:77], v[76:77], v[172:173], v[76:77]
    v_pk_fma_f32 v[78:79], v[78:79], v[174:175], v[78:79]
    v_pk_fma_f32 v[80:81], v[80:81], v[176:177], v[80:81]
    v_pk_fma_f32 v[66:67], v[66:67], v[178:179], v[66:67]
    v_pk_fma_f32 v[68:69], v[68:69], v[180:181], v[68:69]
    v_pk_fma_f32 v[70:71], v[70:71], v[182:183], v[70:71]
    v_pk_fma_f32 v[72:73], v[72:73], v[184:185], v[72:73]
    v_pk_fma_f32 v[66:67], v[146:147], v[74:75], v[66:67]
    v_pk_fma_f32 v[68:69], v[148:149], v[76:77], v[68:69]
    v_pk_fma_f32 v[70:71], v[150:151], v[78:79], v[70:71]
    v_pk_fma_f32 v[72:73], v[152:153], v[80:81], v[72:73]
    v_pk_fma_f32 v[74:75], v[74:75], v[178:179], v[74:75]
    v_pk_fma_f32 v[76:77], v[76:77], v[180:181], v[76:77]
    v_pk_fma_f32 v[78:79], v[78:79], v[182:183], v[78:79]
    v_pk_fma_f32 v[80:81], v[80:81], v[184:185], v[80:81]
    s_setprio 1
    v_exp_f32 v170, v154
    v_mfma_f32_32x32x8_bf16 v[138:153], v[58:59], v[26:27], v[34:49]
    v_exp_f32 v171, v155
    v_exp_f32 v172, v156
    v_exp_f32 v173, v157
    v_exp_f32 v174, v158
    v_smfmac_f32_32x32x32_bf16 v[138:153], v[50:53], v[106:113], v54
    v_exp_f32 v175, v159
    v_exp_f32 v176, v160
    v_exp_f32 v177, v161
    v_exp_f32 v178, v162
    v_exp_f32 v179, v163
    v_exp_f32 v180, v164
    v_exp_f32 v181, v165
    v_exp_f32 v182, v166
    v_exp_f32 v183, v167
    v_exp_f32 v184, v168
    v_exp_f32_e64 v185, v169
    v_pk_fma_f32 v[66:67], v[66:67], v[170:171], v[66:67]
    v_pk_fma_f32 v[68:69], v[68:69], v[172:173], v[68:69]
    v_pk_fma_f32 v[70:71], v[70:71], v[174:175], v[70:71]
    v_pk_fma_f32 v[72:73], v[72:73], v[176:177], v[72:73]
    v_pk_fma_f32 v[66:67], v[154:155], v[74:75], v[66:67]
    v_pk_fma_f32 v[68:69], v[156:157], v[76:77], v[68:69]
    v_pk_fma_f32 v[70:71], v[158:159], v[78:79], v[70:71]
    v_pk_fma_f32 v[72:73], v[160:161], v[80:81], v[72:73]
    v_pk_fma_f32 v[74:75], v[74:75], v[170:171], v[74:75]
    v_pk_fma_f32 v[76:77], v[76:77], v[172:173], v[76:77]
    v_pk_fma_f32 v[78:79], v[78:79], v[174:175], v[78:79]
    v_pk_fma_f32 v[80:81], v[80:81], v[176:177], v[80:81]
    v_pk_fma_f32 v[66:67], v[66:67], v[178:179], v[66:67]
    v_pk_fma_f32 v[68:69], v[68:69], v[180:181], v[68:69]
    v_pk_fma_f32 v[70:71], v[70:71], v[182:183], v[70:71]
    v_pk_fma_f32 v[72:73], v[72:73], v[184:185], v[72:73]
    v_pk_fma_f32 v[66:67], v[162:163], v[74:75], v[66:67]
    v_pk_fma_f32 v[68:69], v[164:165], v[76:77], v[68:69]
    v_pk_fma_f32 v[70:71], v[166:167], v[78:79], v[70:71]
    v_pk_fma_f32 v[72:73], v[168:169], v[80:81], v[72:73]
    v_pk_fma_f32 v[74:75], v[74:75], v[178:179], v[74:75]
    v_pk_fma_f32 v[76:77], v[76:77], v[180:181], v[76:77]
    v_pk_fma_f32 v[78:79], v[78:79], v[182:183], v[78:79]
    v_pk_fma_f32 v[80:81], v[80:81], v[184:185], v[80:81]
    s_cbranch_scc1 L_XF1
    v_cmp_gt_u32 vcc, s30, v23
    v_lshl_add_u64 v[12:13], v[22:23], 0, v[56:57]
    v_add_u32 v61, 16, v61
L_INF:
    v_exp_f32 v170, v138
    v_mfma_f32_32x32x8_bf16 v[154:169], v[58:59], v[28:29], v[34:49]
    v_exp_f32 v171, v139
    v_exp_f32 v172, v140
    v_exp_f32 v173, v141
    v_exp_f32 v174, v142
    v_smfmac_f32_32x32x32_bf16 v[154:169], v[50:53], v[114:121], v54
    v_exp_f32 v175, v143
    v_exp_f32 v176, v144
    v_exp_f32 v177, v145
    v_exp_f32 v178, v146
    v_exp_f32 v179, v147
    v_exp_f32 v180, v148
    v_exp_f32 v181, v149
    v_exp_f32 v182, v150
    v_exp_f32 v183, v151
    v_exp_f32 v184, v152
    v_exp_f32 v185, v153
    s_branch L_LOOPF
L_GSF0:
    s_waitcnt vmcnt(0)
    s_branch L_GF0
L_FSF0:
    s_waitcnt lgkmcnt(0)
    s_branch L_FF0
L_GSF1:
    s_waitcnt vmcnt(0)
    s_branch L_GF1
L_FSF1:
    s_waitcnt lgkmcnt(0)
    s_branch L_FF1
L_XF1:
    v_mov_b32 v13, v15
L_XF0:
    s_setprio 0
    s_cmp_eq_u64 s[24:25], 0
    s_cbranch_scc1 L_SEND
    ds_write_b128 v13, v[66:69] offset:512
    ds_write_b128 v13, v[70:73] offset:640
    ds_write_b128 v13, v[74:77] offset:768
    ds_write_b128 v13, v[78:81] offset:896
L_SEND:
    v_rcp_f32 v170, v74
    v_rcp_f32 v171, v75
    v_rcp_f32 v172, v76
    v_rcp_f32 v173, v77
    v_rcp_f32 v174, v78
    v_rcp_f32 v175, v79
    v_rcp_f32 v176, v80
    v_rcp_f32 v177, v81
    v_pk_add_f32 v[186:187], v[74:75], v[76:77]
    v_pk_mul_f32 v[170:171], v[66:67], v[170:171]
    v_pk_mul_f32 v[172:173], v[68:69], v[172:173]
    v_pk_mul_f32 v[174:175], v[70:71], v[174:175]
    v_pk_mul_f32 v[176:177], v[72:73], v[176:177]
    ds_write_b128 v244, v[170:173] offset:11056
    ds_write_b128 v244, v[174:177] offset:11184
    v_pk_add_f32 v[188:189], v[78:79], v[80:81]
    v_pk_add_f32 v[190:191], v[170:171], v[172:173]
    v_pk_add_f32 v[192:193], v[174:175], v[176:177]
    v_pk_add_f32 v[186:187], v[186:187], v[188:189]
    v_pk_add_f32 v[190:191], v[190:191], v[192:193]
    v_pk_fma_f32 v[186:187], v[190:191], 0, v[186:187] op_sel_hi:[1,0,1]
    v_add_f32 v186, v186, v187
    v_mov_b32 v189, 1
    v_cmpx_ngt_f32 vcc, 0x76800000, v186
    ds_write_b32 v253, v189 offset:8596
    s_mov_b64 exec, -1
L_WEND:
    s_mov_b32 s42, 0xbf317218
    s_mov_b32 s43, s42
    s_waitcnt lgkmcnt(0)
    s_barrier
    ds_read_b128 v[194:197], v245 offset:768
    ds_read_b128 v[198:201], v245 offset:896
    ds_read_b64 v[224:225], v253 offset:8592
    ds_read_b128 v[186:189], v245 offset:512
    ds_read_b128 v[190:193], v245 offset:640
    ds_read_b128 v[202:205], v222 offset:11056
    ds_read_b128 v[206:209], v222 offset:11184
    ds_read_b128 v[210:213], v223 offset:11328
    ds_read_b128 v[214:217], v223 offset:11456
    s_waitcnt lgkmcnt(8)
    v_rcp_f32 v194, v194
    v_rcp_f32 v195, v195
    v_rcp_f32 v196, v196
    v_rcp_f32 v197, v197
    s_waitcnt lgkmcnt(6)
    v_rcp_f32 v198, v198
    v_rcp_f32 v199, v199
    v_rcp_f32 v200, v200
    v_rcp_f32 v201, v201
    v_readfirstlane_b32 s47, v225
    v_readfirstlane_b32 s87, v224
    s_waitcnt lgkmcnt(4)
    v_pk_mul_f32 v[186:187], v[186:187], v[194:195]
    v_pk_mul_f32 v[188:189], v[188:189], v[196:197]
    v_pk_mul_f32 v[190:191], v[190:191], v[198:199]
    v_pk_mul_f32 v[192:193], v[192:193], v[200:201]
    s_andn2_b32 s47, s47, s83
    s_cbranch_scc1 L_RETRY
    v_subrev_f32_dpp v2, v186, v2 wave_shr:1 row_mask:0xf bank_mask:0xf bound_ctrl:1
    v_subrev_f32_dpp v3, v187, v3 wave_shr:1 row_mask:0xf bank_mask:0xf bound_ctrl:1
    v_subrev_f32_dpp v4, v188, v4 wave_shr:1 row_mask:0xf bank_mask:0xf bound_ctrl:1
    v_subrev_f32_dpp v5, v189, v5 wave_shr:1 row_mask:0xf bank_mask:0xf bound_ctrl:1
    v_subrev_f32_dpp v6, v190, v6 wave_shr:1 row_mask:0xf bank_mask:0xf bound_ctrl:1
    v_subrev_f32_dpp v7, v191, v7 wave_shr:1 row_mask:0xf bank_mask:0xf bound_ctrl:1
    v_subrev_f32_dpp v8, v192, v8 wave_shr:1 row_mask:0xf bank_mask:0xf bound_ctrl:1
    v_subrev_f32_dpp v9, v193, v9 wave_shr:1 row_mask:0xf bank_mask:0xf bound_ctrl:1
    s_or_b32 s47, s87, s96
    s_waitcnt lgkmcnt(2)
    v_pk_add_f32 v[186:187], v[186:187], v[202:203]
    v_pk_add_f32 v[188:189], v[188:189], v[204:205]
    v_pk_add_f32 v[190:191], v[190:191], v[206:207]
    v_pk_add_f32 v[192:193], v[192:193], v[208:209]
    s_waitcnt lgkmcnt(0)
    v_pk_add_f32 v[2:3], v[2:3], v[210:211]
    v_pk_add_f32 v[4:5], v[4:5], v[212:213]
    v_pk_add_f32 v[6:7], v[6:7], v[214:215]
    v_pk_add_f32 v[8:9], v[8:9], v[216:217]
    v_pk_add_f32 v[2:3], v[2:3], v[186:187]
    v_pk_add_f32 v[4:5], v[4:5], v[188:189]
    v_pk_add_f32 v[6:7], v[6:7], v[190:191]
    v_pk_add_f32 v[8:9], v[8:9], v[192:193]
    s_cbranch_scc1 L_TLM
L_TLD:
    v_pk_mul_f32 v[186:187], v[2:3], s[42:43]
    v_pk_mul_f32 v[188:189], v[4:5], s[42:43]
    v_pk_mul_f32 v[190:191], v[6:7], s[42:43]
    v_pk_mul_f32 v[192:193], v[8:9], s[42:43]
    v_cvt_pk_bf16_f32 v194, v186, v187
    v_cvt_pk_bf16_f32 v195, v188, v189
    v_cvt_pk_bf16_f32 v196, v190, v191
    v_cvt_pk_bf16_f32 v197, v192, v193
    ds_write_b128 v237, v[194:197] offset:28464
    s_waitcnt lgkmcnt(0)
    s_barrier
    ds_read_b128 v[202:205], v246 offset:28464
    ds_read_b128 v[206:209], v246 offset:28528
    s_waitcnt lgkmcnt(1)
    v_mfma_f32_16x16x32_bf16 v[82:85], v[90:93], v[202:205], v[82:85]
    v_mfma_f32_16x16x32_bf16 v[86:89], v[98:101], v[202:205], v[86:89]
    s_waitcnt lgkmcnt(0)
    v_mfma_f32_16x16x32_bf16 v[82:85], v[94:97], v[206:209], v[82:85]
    v_mfma_f32_16x16x32_bf16 v[86:89], v[102:105], v[206:209], v[86:89]
    s_nop 6
    v_pk_mul_f32 v[186:187], v[82:83], s[90:91]
    v_pk_mul_f32 v[188:189], v[84:85], s[90:91]
    v_pk_mul_f32 v[190:191], v[86:87], s[90:91]
    v_pk_mul_f32 v[192:193], v[88:89], s[90:91]
    v_exp_f32 v186, v186
    v_exp_f32 v187, v187
    v_exp_f32 v188, v188
    v_exp_f32 v189, v189
    v_exp_f32 v190, v190
    v_exp_f32 v191, v191
    v_exp_f32 v192, v192
    v_exp_f32 v193, v193
    v_pk_add_f32 v[186:187], v[186:187], 1.0 op_sel_hi:[1,0]
    v_pk_add_f32 v[188:189], v[188:189], 1.0 op_sel_hi:[1,0]
    v_pk_add_f32 v[190:191], v[190:191], 1.0 op_sel_hi:[1,0]
    v_pk_add_f32 v[192:193], v[192:193], 1.0 op_sel_hi:[1,0]
    v_rcp_f32 v186, v186
    v_rcp_f32 v187, v187
    v_rcp_f32 v188, v188
    v_rcp_f32 v189, v189
    v_rcp_f32 v190, v190
    v_rcp_f32 v191, v191
    v_rcp_f32 v192, v192
    v_rcp_f32 v193, v193
    v_pk_mul_f32 v[186:187], v[82:83], v[186:187]
    v_pk_mul_f32 v[188:189], v[84:85], v[188:189]
    v_pk_mul_f32 v[190:191], v[86:87], v[190:191]
    v_pk_mul_f32 v[192:193], v[88:89], v[192:193]
    v_cvt_pk_bf16_f32 v194, v186, v187
    v_cvt_pk_bf16_f32 v195, v188, v189
    v_cvt_pk_bf16_f32 v196, v190, v191
    v_cvt_pk_bf16_f32 v197, v192, v193
    s_nop 1
    v_permlane16_swap_b32 v194, v196
    v_permlane16_swap_b32 v195, v197
    s_mov_b64 exec, s[38:39]
    buffer_store_dwordx4 v[194:197], v236, s[16:19], s1 offen nt
L_END:
    s_endpgm
L_TLM:
    v_min_i32 v221, 17408, v221
L_TLL:
    v_cmpx_lt_i32 vcc, 544, v221
    s_cbranch_execz L_TLE
    ds_read_b128 v[202:205], v1 offset:11600
    ds_read_b128 v[206:209], v1 offset:11728
    v_add_u32 v221, 0xfffffef0, v221
    v_add_u32 v1, 272, v1
    s_waitcnt lgkmcnt(0)
    v_pk_add_f32 v[2:3], v[2:3], v[202:203]
    v_pk_add_f32 v[4:5], v[4:5], v[204:205]
    v_pk_add_f32 v[6:7], v[6:7], v[206:207]
    v_pk_add_f32 v[8:9], v[8:9], v[208:209]
    s_branch L_TLL
L_TLE:
    s_mov_b64 exec, -1
    s_cmp_lg_u32 s87, 0
    s_cbranch_scc1 L_NEXT
    s_branch L_TLD
L_RAREX:
    v_and_b32 v122, 0xff, v161
    v_bfe_u32 v123, v161, 8, 8
    v_lshrrev_b32 v161, 16, v161
    s_mov_b64 exec, s[78:79]
    ds_add_rtn_u32 v201, v122, v223 offset:8336
    s_mov_b64 exec, s[26:27]
    ds_add_rtn_u32 v202, v123, v223 offset:8336
    s_mov_b64 exec, s[28:29]
    ds_add_rtn_u32 v203, v161, v223 offset:8336
    s_mov_b64 exec, -1
    s_waitcnt lgkmcnt(0)
    ds_write_b32 v201, v158
    ds_write_b32 v202, v159
    ds_write_b32 v203, v160
    s_branch L_RAREXD
L_DENSE:
    v_add_u32 v64, 141568, v227
    v_sub_u32 v219, v64, v63
    ds_write_b32 v252, v219 offset:8608
    ds_read_b32 v112, v112 offset:8608
    ds_read_b32 v113, v113 offset:8608
    ds_read_b32 v141, v141 offset:8608
    ds_read_b32 v114, v114 offset:8608
    ds_read_b32 v115, v115 offset:8608
    ds_read_b32 v145, v145 offset:8608
    ds_read_b32 v116, v116 offset:8608
    ds_read_b32 v117, v117 offset:8608
    ds_read_b32 v149, v149 offset:8608
    ds_read_b32 v118, v118 offset:8608
    ds_read_b32 v119, v119 offset:8608
    ds_read_b32 v153, v153 offset:8608
    s_waitcnt lgkmcnt(0)
    v_add_u32 v186, v112, v186
    ds_write_b32 v186, v138
    v_add_u32 v187, v113, v187
    ds_write_b32 v187, v139
    v_add_u32 v188, v141, v188
    ds_write_b32 v188, v140
    v_add_u32 v189, v114, v189
    ds_write_b32 v189, v142
    v_add_u32 v190, v115, v190
    ds_write_b32 v190, v143
    v_add_u32 v191, v145, v191
    ds_write_b32 v191, v144
    v_add_u32 v192, v116, v192
    ds_write_b32 v192, v146
    v_add_u32 v193, v117, v193
    ds_write_b32 v193, v147
    v_add_u32 v194, v149, v194
    ds_write_b32 v194, v148
    v_add_u32 v195, v118, v195
    ds_write_b32 v195, v150
    v_add_u32 v196, v119, v196
    ds_write_b32 v196, v151
    v_add_u32 v197, v153, v197
    ds_write_b32 v197, v152
    s_cmp_eq_u32 s97, 0
    s_cbranch_scc1 L_DENSED
    ds_read_b32 v120, v120 offset:8608
    ds_read_b32 v121, v121 offset:8608
    ds_read_b32 v157, v157 offset:8608
    s_waitcnt lgkmcnt(0)
    v_add_u32 v198, v120, v198
    ds_write_b32 v198, v154
    v_add_u32 v199, v121, v199
    ds_write_b32 v199, v155
    v_add_u32 v200, v157, v200
    ds_write_b32 v200, v156
    s_cmp_eq_u32 s97, 1
    s_cbranch_scc1 L_DENSED
    ds_read_b32 v122, v122 offset:8608
    ds_read_b32 v123, v123 offset:8608
    ds_read_b32 v161, v161 offset:8608
    s_waitcnt lgkmcnt(0)
    v_add_u32 v201, v122, v201
    ds_write_b32 v201, v158
    v_add_u32 v202, v123, v202
    ds_write_b32 v202, v159
    v_add_u32 v203, v161, v203
    ds_write_b32 v203, v160
    s_branch L_DENSED
L_NONCEW:
    global_load_dword v155, v253, s[34:35] sc1
    s_add_u32 s88, s88, 1
    s_cmp_ge_u32 s88, 0x8000
    s_cbranch_scc1 L_END
    s_waitcnt vmcnt(0)
    s_branch L_PUB
L_PASS:
    s_mov_b32 s88, 0
L_ENTR:
    s_waitcnt lgkmcnt(0)
    v_mov_b32 v111, s89
    s_mov_b32 exec_lo, 0x0f0f0f0f
    s_mov_b32 exec_hi, exec_lo
    buffer_load_dwordx2 v[110:111], v249, s[8:11], 0 offen sc1
    s_mov_b64 exec, -1
    s_add_u32 s88, s88, 1
    s_cmp_ge_u32 s88, 0x8000
    s_cbranch_scc1 L_END
    s_waitcnt vmcnt(0)
    s_branch L_ENT
L_FR:
    buffer_load_dwordx2 v[16:17], v228, s[8:11], 0 offen sc1
    s_add_u32 s88, s88, 1
    s_cmp_ge_u32 s88, 0x8000
    s_cbranch_scc1 L_END
    s_waitcnt vmcnt(0)
    s_branch L_FC
L_HR:
    v_mov_b32 v141, v243
    v_mov_b32 v145, v243
    v_mov_b32 v149, v243
    v_mov_b32 v153, v243
    v_mov_b32 v157, v241
    v_mov_b32 v161, v241
    s_add_u32 s88, s88, 1
    s_cmp_ge_u32 s88, 0x8000
    s_cbranch_scc1 L_END
    s_branch L_LOADS
L_RETRY:
    s_mov_b32 s83, 1
    s_mov_b32 s85, 1
    v_mov_b32 v66, 0
    v_mov_b32 v74, 1.0
    v_mov_b32 v67, 0
    v_mov_b32 v75, 1.0
    v_mov_b32 v68, 0
    v_mov_b32 v76, 1.0
    v_mov_b32 v69, 0
    v_mov_b32 v77, 1.0
    v_mov_b32 v70, 0
    v_mov_b32 v78, 1.0
    v_mov_b32 v71, 0
    v_mov_b32 v79, 1.0
    v_mov_b32 v72, 0
    v_mov_b32 v80, 1.0
    v_mov_b32 v73, 0
    v_mov_b32 v81, 1.0
    s_lshl_b32 s44, s84, 3
    s_lshl_b32 s45, s86, 6
    v_mul_u32_u24 v61, s44, v240
    v_add_u32 v61, s45, v61
    s_waitcnt vmcnt(0) lgkmcnt(0)
    s_branch L_MAIN
L_TOOBIG:
    s_sub_u32 s82, s82, 24
    s_mov_b32 s81, 12
    s_mov_b32 s80, 0x10000000
    v_cmpx_lt_u32 vcc, 63, v10
    v_mov_b32 v239, 0x10000000
    v_mov_b32 v248, 0x10000000
    s_mov_b64 exec, -1
    s_branch L_AGAIN
L_NEXT:
    s_add_u32 s82, s82, s81
    s_add_u32 s80, s80, s81
    v_add_u32 v239, s81, v239
    s_lshl_b32 s44, s81, 3
    v_add_u32 v248, s44, v248
    s_cmp_eq_u32 s81, 12
    s_cselect_b32 s44, 64, 192
    v_add_u32 v250, s44, v250
    v_add_u32 v251, s44, v251
L_AGAIN:
    s_setprio 0
    s_waitcnt vmcnt(0) lgkmcnt(0)
    s_barrier
    s_cmp_eq_u32 s3, 0
    s_cselect_b64 exec, -1, 0
    ds_write_b32 v252, v253 offset:8352
    ds_write_b32 v252, v63 offset:8336
    s_mov_b64 exec, -1
    v_mov_b32 v141, v243
    v_mov_b32 v145, v243
    v_mov_b32 v149, v243
    v_mov_b32 v153, v243
    v_mov_b32 v157, v241
    v_mov_b32 v161, v241
    s_mov_b32 s46, 0x8000801f
    s_waitcnt lgkmcnt(0)
    s_barrier
    s_branch L_PASS
.p2align 6
L_LOOPS:
    s_setprio 0
    ds_read_u16 v18, v12 offset:0
    ds_read_u16 v20, v12 offset:8
    s_cbranch_vccz L_CS0
    s_mov_b64 exec, vcc
    ds_read_b128 v[34:37], v13 offset:1040
    ds_read_b128 v[38:41], v13 offset:1168
    ds_read_b128 v[42:45], v13 offset:1040
    ds_read_b128 v[46:49], v13 offset:1168
L_CS0:
    s_mov_b64 exec, s[20:21]
    ds_read_u16 v26, v14 offset:2
    ds_read_u16 v28, v14 offset:10
    s_lshl_b64 exec, exec, 1
    ds_read_u16_d16_hi v26, v14 offset:2
    ds_read_u16_d16_hi v28, v14 offset:10
    s_lshl_b64 exec, exec, 1
    ds_read_u16 v27, v14 offset:2
    ds_read_u16 v29, v14 offset:10
    s_lshl_b64 exec, exec, 1
    ds_read_u16_d16_hi v27, v14 offset:2
    ds_read_u16_d16_hi v29, v14 offset:10
    s_mov_b64 exec, -1
    ds_read2_b32 v[22:23], v61 offset0:6 offset1:3
    s_cmp_lt_u32 s88, 2
    s_cbranch_scc1 L_GSS0
    s_waitcnt lgkmcnt(9)
    buffer_load_dwordx4 v[106:109], v[18:19], s[12:15], 0 idxen offen offset:0
    buffer_load_dwordx4 v[114:117], v[20:21], s[12:15], 0 idxen offen offset:0
    buffer_load_dwordx4 v[110:113], v[18:19], s[12:15], 0 idxen offen offset:64
    buffer_load_dwordx4 v[118:121], v[20:21], s[12:15], 0 idxen offen offset:64
L_GS0:
    s_cmp_eq_u64 s[24:25], 0
    s_cbranch_scc1 L_FSS0
    ds_write_b128 v15, v[66:69] offset:512
    ds_write_b128 v15, v[70:73] offset:640
    ds_write_b128 v15, v[74:77] offset:768
    ds_write_b128 v15, v[78:81] offset:896
L_FS0:
    s_mov_b64 s[24:25], vcc
    s_sub_u32 s88, s88, 1
    s_waitcnt vmcnt(4) lgkmcnt(4)
    v_pk_add_f32 v[170:171], v[170:171], 1.0 op_sel_hi:[1,0]
    v_pk_add_f32 v[172:173], v[172:173], 1.0 op_sel_hi:[1,0]
    v_pk_add_f32 v[174:175], v[174:175], 1.0 op_sel_hi:[1,0]
    v_pk_add_f32 v[176:177], v[176:177], 1.0 op_sel_hi:[1,0]
    v_pk_add_f32 v[178:179], v[178:179], 1.0 op_sel_hi:[1,0]
    v_pk_add_f32 v[180:181], v[180:181], 1.0 op_sel_hi:[1,0]
    v_pk_add_f32 v[182:183], v[182:183], 1.0 op_sel_hi:[1,0]
    v_pk_add_f32 v[184:185], v[184:185], 1.0 op_sel_hi:[1,0]
    v_rcp_f32 v170, v170
    v_rcp_f32 v171, v171
    v_rcp_f32 v172, v172
    v_rcp_f32 v173, v173
    v_rcp_f32 v174, v174
    v_rcp_f32 v175, v175
    v_rcp_f32 v176, v176
    v_rcp_f32 v177, v177
    v_rcp_f32 v178, v178
    v_rcp_f32 v179, v179
    v_rcp_f32 v180, v180
    v_rcp_f32 v181, v181
    v_rcp_f32 v182, v182
    v_rcp_f32 v183, v183
    v_rcp_f32 v184, v184
    v_rcp_f32 v185, v185
    s_setprio 1
    s_nop 0
    v_pk_fma_f32 v[66:67], v[138:139], v[170:171], v[66:67]
    v_pk_fma_f32 v[68:69], v[140:141], v[172:173], v[68:69]
    v_pk_fma_f32 v[70:71], v[142:143], v[174:175], v[70:71]
    v_pk_fma_f32 v[72:73], v[144:145], v[176:177], v[72:73]
    v_pk_fma_f32 v[66:67], v[146:147], v[178:179], v[66:67]
    v_pk_fma_f32 v[68:69], v[148:149], v[180:181], v[68:69]
    v_pk_fma_f32 v[70:71], v[150:151], v[182:183], v[70:71]
    v_pk_fma_f32 v[72:73], v[152:153], v[184:185], v[72:73]
    v_mfma_f32_32x32x8_bf16 v[138:153], v[58:59], v[26:27], v[34:49]
    v_exp_f32 v170, v154
    v_exp_f32 v171, v155
    v_exp_f32 v172, v156
    v_exp_f32 v173, v157
    v_smfmac_f32_32x32x32_bf16 v[138:153], v[50:53], v[122:129], v54
    v_exp_f32 v174, v158
    v_exp_f32 v175, v159
    v_exp_f32 v176, v160
    v_exp_f32 v177, v161
    v_exp_f32 v178, v162
    v_exp_f32 v179, v163
    v_exp_f32 v180, v164
    v_exp_f32 v181, v165
    v_exp_f32 v182, v166
    v_exp_f32 v183, v167
    v_exp_f32 v184, v168
    v_exp_f32 v185, v169
    v_pk_add_f32 v[170:171], v[170:171], 1.0 op_sel_hi:[1,0]
    v_pk_add_f32 v[172:173], v[172:173], 1.0 op_sel_hi:[1,0]
    v_pk_add_f32 v[174:175], v[174:175], 1.0 op_sel_hi:[1,0]
    v_pk_add_f32 v[176:177], v[176:177], 1.0 op_sel_hi:[1,0]
    v_pk_add_f32 v[178:179], v[178:179], 1.0 op_sel_hi:[1,0]
    v_pk_add_f32 v[180:181], v[180:181], 1.0 op_sel_hi:[1,0]
    v_pk_add_f32 v[182:183], v[182:183], 1.0 op_sel_hi:[1,0]
    v_pk_add_f32 v[184:185], v[184:185], 1.0 op_sel_hi:[1,0]
    v_rcp_f32 v170, v170
    v_rcp_f32 v171, v171
    v_rcp_f32 v172, v172
    v_rcp_f32 v173, v173
    v_rcp_f32 v174, v174
    v_rcp_f32 v175, v175
    v_rcp_f32 v176, v176
    v_rcp_f32 v177, v177
    v_rcp_f32 v178, v178
    v_rcp_f32 v179, v179
    v_rcp_f32 v180, v180
    v_rcp_f32 v181, v181
    v_rcp_f32 v182, v182
    v_rcp_f32 v183, v183
    v_rcp_f32 v184, v184
    v_rcp_f32 v185, v185
    v_pk_fma_f32 v[66:67], v[154:155], v[170:171], v[66:67]
    v_pk_fma_f32 v[68:69], v[156:157], v[172:173], v[68:69]
    v_pk_fma_f32 v[70:71], v[158:159], v[174:175], v[70:71]
    v_pk_fma_f32 v[72:73], v[160:161], v[176:177], v[72:73]
    v_pk_fma_f32 v[66:67], v[162:163], v[178:179], v[66:67]
    v_pk_fma_f32 v[68:69], v[164:165], v[180:181], v[68:69]
    v_pk_fma_f32 v[70:71], v[166:167], v[182:183], v[70:71]
    v_pk_fma_f32 v[72:73], v[168:169], v[184:185], v[72:73]
    s_cbranch_scc1 L_XS0
    v_cmp_gt_u32 vcc, s30, v23
    v_lshl_add_u64 v[14:15], v[22:23], 0, v[56:57]
    v_exp_f32_e64 v170, v138
    v_mfma_f32_32x32x8_bf16 v[154:169], v[58:59], v[28:29], v[34:49]
    v_exp_f32 v171, v139
    v_exp_f32 v172, v140
    v_exp_f32 v173, v141
    v_exp_f32 v174, v142
    v_smfmac_f32_32x32x32_bf16 v[154:169], v[50:53], v[130:137], v54
    v_exp_f32 v175, v143
    v_exp_f32 v176, v144
    v_exp_f32 v177, v145
    v_exp_f32 v178, v146
    v_exp_f32 v179, v147
    v_exp_f32 v180, v148
    v_exp_f32 v181, v149
    v_exp_f32 v182, v150
    v_exp_f32 v183, v151
    v_exp_f32 v184, v152
    v_exp_f32 v185, v153
    s_setprio 0
    ds_read_u16 v18, v14 offset:0
    ds_read_u16 v20, v14 offset:8
    s_cbranch_vccz L_CS1
    s_mov_b64 exec, vcc
    ds_read_b128 v[34:37], v15 offset:1040
    ds_read_b128 v[38:41], v15 offset:1168
    ds_read_b128 v[42:45], v15 offset:1040
    ds_read_b128 v[46:49], v15 offset:1168
L_CS1:
    s_mov_b64 exec, s[20:21]
    ds_read_u16 v26, v12 offset:2
    ds_read_u16 v28, v12 offset:10
    s_lshl_b64 exec, exec, 1
    ds_read_u16_d16_hi v26, v12 offset:2
    ds_read_u16_d16_hi v28, v12 offset:10
    s_lshl_b64 exec, exec, 1
    ds_read_u16 v27, v12 offset:2
    ds_read_u16 v29, v12 offset:10
    s_lshl_b64 exec, exec, 1
    ds_read_u16_d16_hi v27, v12 offset:2
    ds_read_u16_d16_hi v29, v12 offset:10
    s_mov_b64 exec, -1
    ds_read2_b32 v[22:23], v61 offset0:8 offset1:5
    s_cmp_lt_u32 s88, 2
    s_cbranch_scc1 L_GSS1
    s_waitcnt lgkmcnt(9)
    buffer_load_dwordx4 v[122:125], v[18:19], s[12:15], 0 idxen offen offset:0
    buffer_load_dwordx4 v[130:133], v[20:21], s[12:15], 0 idxen offen offset:0
    buffer_load_dwordx4 v[126:129], v[18:19], s[12:15], 0 idxen offen offset:64
    buffer_load_dwordx4 v[134:137], v[20:21], s[12:15], 0 idxen offen offset:64
L_GS1:
    s_cmp_eq_u64 s[24:25], 0
    s_cbranch_scc1 L_FSS1
    ds_write_b128 v13, v[66:69] offset:512
    ds_write_b128 v13, v[70:73] offset:640
    ds_write_b128 v13, v[74:77] offset:768
    ds_write_b128 v13, v[78:81] offset:896
L_FS1:
    s_mov_b64 s[24:25], vcc
    s_sub_u32 s88, s88, 1
    s_waitcnt vmcnt(4) lgkmcnt(4)
    s_nop 0
    v_pk_add_f32 v[170:171], v[170:171], 1.0 op_sel_hi:[1,0]
    v_pk_add_f32 v[172:173], v[172:173], 1.0 op_sel_hi:[1,0]
    v_pk_add_f32 v[174:175], v[174:175], 1.0 op_sel_hi:[1,0]
    v_pk_add_f32 v[176:177], v[176:177], 1.0 op_sel_hi:[1,0]
    v_pk_add_f32 v[178:179], v[178:179], 1.0 op_sel_hi:[1,0]
    v_pk_add_f32 v[180:181], v[180:181], 1.0 op_sel_hi:[1,0]
    v_pk_add_f32 v[182:183], v[182:183], 1.0 op_sel_hi:[1,0]
    v_pk_add_f32 v[184:185], v[184:185], 1.0 op_sel_hi:[1,0]
    v_rcp_f32 v170, v170
    v_rcp_f32 v171, v171
    v_rcp_f32 v172, v172
    v_rcp_f32 v173, v173
    v_rcp_f32 v174, v174
    v_rcp_f32 v175, v175
    v_rcp_f32 v176, v176
    v_rcp_f32 v177, v177
    v_rcp_f32 v178, v178
    v_rcp_f32 v179, v179
    v_rcp_f32 v180, v180
    v_rcp_f32 v181, v181
    v_rcp_f32 v182, v182
    v_rcp_f32 v183, v183
    v_rcp_f32 v184, v184
    v_rcp_f32 v185, v185
    s_setprio 1
    s_nop 0
    v_pk_fma_f32 v[66:67], v[138:139], v[170:171], v[66:67]
    v_pk_fma_f32 v[68:69], v[140:141], v[172:173], v[68:69]
    v_pk_fma_f32 v[70:71], v[142:143], v[174:175], v[70:71]
    v_pk_fma_f32 v[72:73], v[144:145], v[176:177], v[72:73]
    v_pk_fma_f32 v[66:67], v[146:147], v[178:179], v[66:67]
    v_pk_fma_f32 v[68:69], v[148:149], v[180:181], v[68:69]
    v_pk_fma_f32 v[70:71], v[150:151], v[182:183], v[70:71]
    v_pk_fma_f32 v[72:73], v[152:153], v[184:185], v[72:73]
    v_mfma_f32_32x32x8_bf16 v[138:153], v[58:59], v[26:27], v[34:49]
    v_exp_f32 v170, v154
    v_exp_f32 v171, v155
    v_exp_f32 v172, v156
    v_exp_f32 v173, v157
    v_smfmac_f32_32x32x32_bf16 v[138:153], v[50:53], v[106:113], v54
    v_exp_f32 v174, v158
    v_exp_f32 v175, v159
    v_exp_f32 v176, v160
    v_exp_f32 v177, v161
    v_exp_f32 v178, v162
    v_exp_f32 v179, v163
    v_exp_f32 v180, v164
    v_exp_f32 v181, v165
    v_exp_f32 v182, v166
    v_exp_f32 v183, v167
    v_exp_f32 v184, v168
    v_exp_f32 v185, v169
    v_pk_add_f32 v[170:171], v[170:171], 1.0 op_sel_hi:[1,0]
    v_pk_add_f32 v[172:173], v[172:173], 1.0 op_sel_hi:[1,0]
    v_pk_add_f32 v[174:175], v[174:175], 1.0 op_sel_hi:[1,0]
    v_pk_add_f32 v[176:177], v[176:177], 1.0 op_sel_hi:[1,0]
    v_pk_add_f32 v[178:179], v[178:179], 1.0 op_sel_hi:[1,0]
    v_pk_add_f32 v[180:181], v[180:181], 1.0 op_sel_hi:[1,0]
    v_pk_add_f32 v[182:183], v[182:183], 1.0 op_sel_hi:[1,0]
    v_pk_add_f32 v[184:185], v[184:185], 1.0 op_sel_hi:[1,0]
    v_rcp_f32 v170, v170
    v_rcp_f32 v171, v171
    v_rcp_f32 v172, v172
    v_rcp_f32 v173, v173
    v_rcp_f32 v174, v174
    v_rcp_f32 v175, v175
    v_rcp_f32 v176, v176
    v_rcp_f32 v177, v177
    v_rcp_f32 v178, v178
    v_rcp_f32 v179, v179
    v_rcp_f32 v180, v180
    v_rcp_f32 v181, v181
    v_rcp_f32 v182, v182
    v_rcp_f32 v183, v183
    v_rcp_f32 v184, v184
    v_rcp_f32 v185, v185
    v_pk_fma_f32 v[66:67], v[154:155], v[170:171], v[66:67]
    v_pk_fma_f32 v[68:69], v[156:157], v[172:173], v[68:69]
    v_pk_fma_f32 v[70:71], v[158:159], v[174:175], v[70:71]
    v_pk_fma_f32 v[72:73], v[160:161], v[176:177], v[72:73]
    v_pk_fma_f32 v[66:67], v[162:163], v[178:179], v[66:67]
    v_pk_fma_f32 v[68:69], v[164:165], v[180:181], v[68:69]
    v_pk_fma_f32 v[70:71], v[166:167], v[182:183], v[70:71]
    v_pk_fma_f32 v[72:73], v[168:169], v[184:185], v[72:73]
    s_cbranch_scc1 L_XS1
    v_cmp_gt_u32 vcc, s30, v23
    v_lshl_add_u64 v[12:13], v[22:23], 0, v[56:57]
    v_add_u32 v61, 16, v61
L_INS:
    v_exp_f32 v170, v138
    v_mfma_f32_32x32x8_bf16 v[154:169], v[58:59], v[28:29], v[34:49]
    v_exp_f32 v171, v139
    v_exp_f32 v172, v140
    v_exp_f32 v173, v141
    v_exp_f32 v174, v142
    v_smfmac_f32_32x32x32_bf16 v[154:169], v[50:53], v[114:121], v54
    v_exp_f32 v175, v143
    v_exp_f32 v176, v144
    v_exp_f32 v177, v145
    v_exp_f32 v178, v146
    v_exp_f32 v179, v147
    v_exp_f32 v180, v148
    v_exp_f32 v181, v149
    v_exp_f32 v182, v150
    v_exp_f32 v183, v151
    v_exp_f32 v184, v152
    v_exp_f32 v185, v153
    s_branch L_LOOPS
L_GSS0:
    s_waitcnt vmcnt(0)
    s_branch L_GS0
L_FSS0:
    s_waitcnt lgkmcnt(0)
    s_branch L_FS0
L_GSS1:
    s_waitcnt vmcnt(0)
    s_branch L_GS1
L_FSS1:
    s_waitcnt lgkmcnt(0)
    s_branch L_FS1
L_XS1:
    v_mov_b32 v13, v15
L_XS0:
    s_setprio 0
    s_cmp_eq_u64 s[24:25], 0
    s_cbranch_scc1 L_SEND
    ds_write_b128 v13, v[66:69] offset:512
    ds_write_b128 v13, v[70:73] offset:640
    ds_write_b128 v13, v[74:77] offset:768
    ds_write_b128 v13, v[78:81] offset:896
    s_branch L_SEND
.p2align 8
L_TAB:
.long 0x3f80, 0x0, 0x0, 0x0, 0x3f800000, 0x0, 0x0, 0x0
.long 0x3f80, 0x0, 0x0, 0x0, 0x3f800000, 0x0, 0x0, 0x0
.long 0x0, 0x0, 0x0, 0x0, 0x0, 0x0, 0x0, 0x0
.long 0x0, 0x0, 0x0, 0x0, 0x0, 0x0, 0x0, 0x0
.long 0x0, 0x3f80, 0x0, 0x0, 0x0, 0x3f800000, 0x0, 0x0
.long 0x0, 0x3f80, 0x0, 0x0, 0x0, 0x3f800000, 0x0, 0x0
.long 0x0, 0x0, 0x0, 0x0, 0x0, 0x0, 0x0, 0x0
.long 0x0, 0x0, 0x0, 0x0, 0x0, 0x0, 0x0, 0x0
.long 0x0, 0x0, 0x3f80, 0x0, 0x0, 0x0, 0x3f800000, 0x0
.long 0x0, 0x0, 0x3f80, 0x0, 0x0, 0x0, 0x3f800000, 0x0
.long 0x0, 0x0, 0x0, 0x0, 0x0, 0x0, 0x0, 0x0
.long 0x0, 0x0, 0x0, 0x0, 0x0, 0x0, 0x0, 0x0
.long 0x0, 0x0, 0x0, 0x3f80, 0x0, 0x0, 0x0, 0x3f800000
.long 0x0, 0x0, 0x0, 0x3f80, 0x0, 0x0, 0x0, 0x3f800000
.long 0x0, 0x0, 0x0, 0x0, 0x0, 0x0, 0x0, 0x0
.long 0x0, 0x0, 0x0, 0x0, 0x0, 0x0, 0x0, 0x0
.long 0x0, 0x0, 0x0, 0x0, 0x0, 0x0, 0x0, 0x0
.long 0x0, 0x0, 0x0, 0x0, 0x0, 0x0, 0x0, 0x0
.long 0x3f80, 0x0, 0x0, 0x0, 0x3f800000, 0x0, 0x0, 0x0
.long 0x3f80, 0x0, 0x0, 0x0, 0x3f800000, 0x0, 0x0, 0x0
.long 0x0, 0x0, 0x0, 0x0, 0x0, 0x0, 0x0, 0x0
.long 0x0, 0x0, 0x0, 0x0, 0x0, 0x0, 0x0, 0x0
.long 0x0, 0x3f80, 0x0, 0x0, 0x0, 0x3f800000, 0x0, 0x0
.long 0x0, 0x3f80, 0x0, 0x0, 0x0, 0x3f800000, 0x0, 0x0
.long 0x0, 0x0, 0x0, 0x0, 0x0, 0x0, 0x0, 0x0
.long 0x0, 0x0, 0x0, 0x0, 0x0, 0x0, 0x0, 0x0
.long 0x0, 0x0, 0x3f80, 0x0, 0x0, 0x0, 0x3f800000, 0x0
.long 0x0, 0x0, 0x3f80, 0x0, 0x0, 0x0, 0x3f800000, 0x0
.long 0x0, 0x0, 0x0, 0x0, 0x0, 0x0, 0x0, 0x0
.long 0x0, 0x0, 0x0, 0x0, 0x0, 0x0, 0x0, 0x0
.long 0x0, 0x0, 0x0, 0x3f80, 0x0, 0x0, 0x0, 0x3f800000
.long 0x0, 0x0, 0x0, 0x3f80, 0x0, 0x0, 0x0, 0x3f800000
.long 0x4444, 0xffffffff, 0x0, 0x0, 0x4444, 0xffffffff, 0x0, 0x10
.long 0xeeee, 0xffffffff, 0x0, 0x20, 0xeeee, 0xffffffff, 0x0, 0x30
.long 0x4444, 0xffffffff, 0x0, 0x0, 0x4444, 0xffffffff, 0x0, 0x10
.long 0xeeee, 0xffffffff, 0x0, 0x20, 0xeeee, 0xffffffff, 0x0, 0x30
.long 0x4444, 0xffffffff, 0x0, 0x0, 0x4444, 0xffffffff, 0x0, 0x10
.long 0xeeee, 0xffffffff, 0x0, 0x20, 0xeeee, 0xffffffff, 0x0, 0x30
.long 0x4444, 0xffffffff, 0x0, 0x0, 0x4444, 0xffffffff, 0x0, 0x10
.long 0xeeee, 0xffffffff, 0x0, 0x20, 0xeeee, 0xffffffff, 0x0, 0x30
.long 0x4444, 0x0, 0x0, 0x0, 0x4444, 0x0, 0x0, 0x10
.long 0xeeee, 0x0, 0x0, 0x20, 0xeeee, 0x0, 0x0, 0x30
.long 0x4444, 0x0, 0x0, 0x0, 0x4444, 0x0, 0x0, 0x10
.long 0xeeee, 0x0, 0x0, 0x20, 0xeeee, 0x0, 0x0, 0x30
.long 0x4444, 0x0, 0x0, 0x0, 0x4444, 0x0, 0x0, 0x10
.long 0xeeee, 0x0, 0x0, 0x20, 0xeeee, 0x0, 0x0, 0x30
.long 0x4444, 0x0, 0x0, 0x0, 0x4444, 0x0, 0x0, 0x10
.long 0xeeee, 0x0, 0x0, 0x20, 0xeeee, 0x0, 0x0, 0x30
.long 0x4444, 0x0, 0x4, 0x40, 0x4444, 0x0, 0x4, 0x50
.long 0xeeee, 0x0, 0x4, 0x60, 0xeeee, 0x0, 0x4, 0x70
.long 0x4444, 0x0, 0x4, 0x40, 0x4444, 0x0, 0x4, 0x50
.long 0xeeee, 0x0, 0x4, 0x60, 0xeeee, 0x0, 0x4, 0x70
.long 0x4444, 0x0, 0x4, 0x40, 0x4444, 0x0, 0x4, 0x50
.long 0xeeee, 0x0, 0x4, 0x60, 0xeeee, 0x0, 0x4, 0x70
.long 0x4444, 0x0, 0x4, 0x40, 0x4444, 0x0, 0x4, 0x50
.long 0xeeee, 0x0, 0x4, 0x60, 0xeeee, 0x0, 0x4, 0x70
.long 0x4444, 0xffffffff, 0x4, 0x40, 0x4444, 0xffffffff, 0x4, 0x50
.long 0xeeee, 0xffffffff, 0x4, 0x60, 0xeeee, 0xffffffff, 0x4, 0x70
.long 0x4444, 0xffffffff, 0x4, 0x40, 0x4444, 0xffffffff, 0x4, 0x50
.long 0xeeee, 0xffffffff, 0x4, 0x60, 0xeeee, 0xffffffff, 0x4, 0x70
.long 0x4444, 0xffffffff, 0x4, 0x40, 0x4444, 0xffffffff, 0x4, 0x50
.long 0xeeee, 0xffffffff, 0x4, 0x60, 0xeeee, 0xffffffff, 0x4, 0x70
.long 0x4444, 0xffffffff, 0x4, 0x40, 0x4444, 0xffffffff, 0x4, 0x50
.long 0xeeee, 0xffffffff, 0x4, 0x60, 0xeeee, 0xffffffff, 0x4, 0x70
.long 0x0, 0x0, 0x0, 0x0, 0x0, 0x0, 0x0, 0x0
.long 0x0, 0x0, 0x0, 0x0, 0x0, 0x0, 0x0, 0x0
.long 0x0, 0x0, 0x0, 0x0, 0x0, 0x0, 0x0, 0x0
.long 0x0, 0x0, 0x0, 0x0, 0x0, 0x0, 0x0, 0x0
.long 0x0, 0x0, 0x0, 0x0, 0x0, 0x0, 0x0, 0x0
.long 0x0, 0x0, 0x0, 0x0, 0x0, 0x0, 0x0, 0x0
.long 0x0, 0x0, 0x0, 0x0, 0x0, 0x0, 0x0, 0x0
.long 0x0, 0x0, 0x0, 0x0, 0x0, 0x0, 0x0, 0x0
.long 0x0, 0x0, 0x0, 0x0, 0x0, 0x0, 0x0, 0x0
.long 0x0, 0x0, 0x0, 0x0, 0x0, 0x0, 0x0, 0x0
.long 0x0, 0x0, 0x0, 0x0, 0x0, 0x0, 0x0, 0x0
.long 0x0, 0x0, 0x0, 0x0, 0x0, 0x0, 0x0, 0x0
.long 0x0, 0x0, 0x0, 0x0, 0x0, 0x0, 0x0, 0x0
.long 0x0, 0x0, 0x0, 0x0, 0x0, 0x0, 0x0, 0x0
.long 0x0, 0x0, 0x0, 0x0, 0x0, 0x0, 0x0, 0x0
.long 0x0, 0x0, 0x0, 0x0, 0x0, 0x0, 0x0, 0x0
.long 0x0, 0x0, 0x0, 0x0, 0x0, 0x0, 0x0, 0x0
.long 0x0, 0x0, 0x0, 0x0, 0x0, 0x0, 0x0, 0x0
.long 0x0, 0x0, 0x0, 0x0, 0x0, 0x0, 0x0, 0x0
.long 0x0, 0x0, 0x0, 0x0, 0x0, 0x0, 0x0, 0x0
.long 0x0, 0x0, 0x0, 0x0, 0x0, 0x0, 0x0, 0x0
.long 0x0, 0x0, 0x0, 0x0, 0x0, 0x0, 0x0, 0x0
.long 0x0, 0x0, 0x0, 0x0, 0x0, 0x0, 0x0, 0x0
.long 0x0, 0x0, 0x0, 0x0, 0x0, 0x0, 0x0, 0x0
.long 0x0, 0x0, 0x0, 0x0, 0x0, 0x0, 0x0, 0x0
.long 0x0, 0x0, 0x0, 0x0, 0x0, 0x0, 0x0, 0x0
.long 0x0, 0x0, 0x0, 0x0, 0x0, 0x0, 0x0, 0x0
.long 0x0, 0x0, 0x0, 0x0, 0x0, 0x0, 0x0, 0x0
.long 0x0, 0x0, 0x0, 0x0, 0x0, 0x0, 0x0, 0x0
.long 0x0, 0x0, 0x0, 0x0, 0x0, 0x0, 0x0, 0x0
.long 0x0, 0x0, 0x0, 0x0, 0x0, 0x0, 0x0, 0x0
.long 0x0, 0x0, 0x0, 0x0, 0x0, 0x0, 0x0, 0x0
.long 0x0, 0x0, 0x0, 0x0, 0x0, 0x0, 0x0, 0x0
.long 0x0, 0x0, 0x0, 0x0, 0x0, 0x0, 0x0, 0x0
.long 0x0, 0x0, 0x0, 0x0, 0x0, 0x0, 0x0, 0x0
.long 0x0, 0x0, 0x0, 0x0, 0x0, 0x0, 0x0, 0x0
.long 0x0, 0x0, 0x0, 0x0, 0x0, 0x0, 0x0, 0x0
.long 0x0, 0x0, 0x0, 0x0, 0x0, 0x0, 0x0, 0x0
.long 0x0, 0x0, 0x0, 0x0, 0x0, 0x0, 0x0, 0x0
.long 0x0, 0x0, 0x0, 0x0, 0x0, 0x0, 0x0, 0x0
.long 0x0, 0x0, 0x0, 0x0, 0x0, 0x0, 0x0, 0x0
.long 0x0, 0x0, 0x0, 0x0, 0x0, 0x0, 0x0, 0x0
.long 0x0, 0x0, 0x0, 0x0, 0x0, 0x0, 0x0, 0x0
.long 0x0, 0x0, 0x0, 0x0, 0x0, 0x0, 0x0, 0x0
.long 0x0, 0x0, 0x0, 0x0, 0x0, 0x0, 0x0, 0x0
.long 0x0, 0x0, 0x0, 0x0, 0x0, 0x0, 0x0, 0x0
.long 0x0, 0x0, 0x0, 0x0, 0x0, 0x0, 0x0, 0x0
.long 0x0, 0x0, 0x0, 0x0, 0x0, 0x0, 0x0, 0x0
.long 0x0, 0x0, 0x0, 0x0, 0x0, 0x0, 0x0, 0x0
.long 0x0, 0x0, 0x0, 0x0, 0x0, 0x0, 0x0, 0x0
.long 0x0, 0x0, 0x0, 0x0, 0x0, 0x0, 0x0, 0x0
.long 0x0, 0x0, 0x0, 0x0, 0x0, 0x0, 0x0, 0x0
.long 0x0, 0x0, 0x0, 0x0, 0x0, 0x0, 0x0, 0x0
.long 0x0, 0x0, 0x0, 0x0, 0x0, 0x0, 0x0, 0x0
.long 0x0, 0x0, 0x0, 0x0, 0x0, 0x0, 0x0, 0x0
.long 0x0, 0x0, 0x0, 0x0, 0x0, 0x0, 0x0, 0x0
.long 0x0, 0x0, 0x0, 0x0, 0x0, 0x0, 0x0, 0x0
.long 0x0, 0x0, 0x0, 0x0, 0x0, 0x0, 0x0, 0x0
.long 0x0, 0x0, 0x0, 0x0, 0x0, 0x0, 0x0, 0x0
.long 0x0, 0x0, 0x0, 0x0, 0x0, 0x0, 0x0, 0x0
.long 0x0, 0x0, 0x0, 0x0, 0x0, 0x0, 0x0, 0x0
.long 0x0, 0x0, 0x0, 0x0, 0x0, 0x0, 0x0, 0x0
.long 0x0, 0x0, 0x0, 0x0, 0x0, 0x0, 0x0, 0x0
.long 0x0, 0x0, 0x0, 0x0, 0x0, 0x0, 0x0, 0x0
.long 0x16900, 0x1a900, 0x20900, 0x0, 0x16990, 0x1a908, 0x20908, 0x2
.long 0x16a20, 0x1a910, 0x20910, 0x4, 0x16ab0, 0x1a918, 0x20918, 0x6
.long 0x16b40, 0x1a980, 0x20980, 0x40, 0x16bd0, 0x1a988, 0x20988, 0x42
.long 0x16c60, 0x1a990, 0x20990, 0x44, 0x16cf0, 0x1a998, 0x20998, 0x46
.long 0x16d00, 0x1aa20, 0x20a20, 0x20, 0x16d90, 0x1aa28, 0x20a28, 0x22
.long 0x16e20, 0x1aa30, 0x20a30, 0x24, 0x16eb0, 0x1aa38, 0x20a38, 0x26
.long 0x16f40, 0x1aaa0, 0x20aa0, 0x60, 0x16fd0, 0x1aaa8, 0x20aa8, 0x62
.long 0x17060, 0x1aab0, 0x20ab0, 0x64, 0x170f0, 0x1aab8, 0x20ab8, 0x66
.long 0x16910, 0x1ad40, 0x20b00, 0x0, 0x16980, 0x1ad48, 0x20b08, 0x2
.long 0x16a30, 0x1ad50, 0x20b10, 0x4, 0x16aa0, 0x1ad58, 0x20b18, 0x6
.long 0x16b50, 0x1adc0, 0x20b80, 0x40, 0x16bc0, 0x1adc8, 0x20b88, 0x42
.long 0x16c70, 0x1add0, 0x20b90, 0x44, 0x16ce0, 0x1add8, 0x20b98, 0x46
.long 0x16d10, 0x1ae60, 0x20c20, 0x20, 0x16d80, 0x1ae68, 0x20c28, 0x22
.long 0x16e30, 0x1ae70, 0x20c30, 0x24, 0x16ea0, 0x1ae78, 0x20c38, 0x26
.long 0x16f50, 0x1aee0, 0x20ca0, 0x60, 0x16fc0, 0x1aee8, 0x20ca8, 0x62
.long 0x17070, 0x1aef0, 0x20cb0, 0x64, 0x170e0, 0x1aef8, 0x20cb8, 0x66
.long 0x16920, 0x1b100, 0x20d40, 0x0, 0x169b0, 0x1b108, 0x20d48, 0x2
.long 0x16a00, 0x1b110, 0x20d50, 0x4, 0x16a90, 0x1b118, 0x20d58, 0x6
.long 0x16b60, 0x1b180, 0x20dc0, 0x40, 0x16bf0, 0x1b188, 0x20dc8, 0x42
.long 0x16c40, 0x1b190, 0x20dd0, 0x44, 0x16cd0, 0x1b198, 0x20dd8, 0x46
.long 0x16d20, 0x1b220, 0x20e60, 0x20, 0x16db0, 0x1b228, 0x20e68, 0x22
.long 0x16e00, 0x1b230, 0x20e70, 0x24, 0x16e90, 0x1b238, 0x20e78, 0x26
.long 0x16f60, 0x1b2a0, 0x20ee0, 0x60, 0x16ff0, 0x1b2a8, 0x20ee8, 0x62
.long 0x17040, 0x1b2b0, 0x20ef0, 0x64, 0x170d0, 0x1b2b8, 0x20ef8, 0x66
.long 0x16930, 0x1b540, 0x20f40, 0x0, 0x169a0, 0x1b548, 0x20f48, 0x2
.long 0x16a10, 0x1b550, 0x20f50, 0x4, 0x16a80, 0x1b558, 0x20f58, 0x6
.long 0x16b70, 0x1b5c0, 0x20fc0, 0x40, 0x16be0, 0x1b5c8, 0x20fc8, 0x42
.long 0x16c50, 0x1b5d0, 0x20fd0, 0x44, 0x16cc0, 0x1b5d8, 0x20fd8, 0x46
.long 0x16d30, 0x1b660, 0x21060, 0x20, 0x16da0, 0x1b668, 0x21068, 0x22
.long 0x16e10, 0x1b670, 0x21070, 0x24, 0x16e80, 0x1b678, 0x21078, 0x26
.long 0x16f70, 0x1b6e0, 0x210e0, 0x60, 0x16fe0, 0x1b6e8, 0x210e8, 0x62
.long 0x17050, 0x1b6f0, 0x210f0, 0x64, 0x170c0, 0x1b6f8, 0x210f8, 0x66
.long 0x0, 0x18900, 0x9d10, 0x0, 0x10, 0x18910, 0xa120, 0x90
.long 0x20, 0x18920, 0xa530, 0x120, 0x30, 0x18930, 0xa940, 0x1b0
.long 0x80, 0x18990, 0xad50, 0x240, 0x90, 0x18980, 0xb160, 0x2d0
.long 0xa0, 0x189b0, 0xb570, 0x360, 0xb0, 0x189a0, 0xb980, 0x3f0
.long 0x100, 0x18a20, 0xbd90, 0x480, 0x110, 0x18a30, 0xc1a0, 0x510
.long 0x120, 0x18a00, 0xc5b0, 0x5a0, 0x130, 0x18a10, 0xc9c0, 0x630
.long 0x180, 0x18ab0, 0xcdd0, 0x6c0, 0x190, 0x18aa0, 0xd1e0, 0x750
.long 0x1a0, 0x18a90, 0xd5f0, 0x7e0, 0x1b0, 0x18a80, 0xda00, 0x870
.long 0x200, 0x18b40, 0x9d20, 0x10, 0x210, 0x18b50, 0xa130, 0xa0
.long 0x220, 0x18b60, 0xa540, 0x130, 0x230, 0x18b70, 0xa950, 0x1c0
.long 0x280, 0x18bd0, 0xad60, 0x250, 0x290, 0x18bc0, 0xb170, 0x2e0
.long 0x2a0, 0x18bf0, 0xb580, 0x370, 0x2b0, 0x18be0, 0xb990, 0x400
.long 0x300, 0x18c60, 0xbda0, 0x490, 0x310, 0x18c70, 0xc1b0, 0x520
.long 0x320, 0x18c40, 0xc5c0, 0x5b0, 0x330, 0x18c50, 0xc9d0, 0x640
.long 0x380, 0x18cf0, 0xcde0, 0x6d0, 0x390, 0x18ce0, 0xd1f0, 0x760
.long 0x3a0, 0x18cd0, 0xd600, 0x7f0, 0x3b0, 0x18cc0, 0xda10, 0x880
.long 0x400, 0x18d00, 0x9d30, 0x20, 0x410, 0x18d10, 0xa140, 0xb0
.long 0x420, 0x18d20, 0xa550, 0x140, 0x430, 0x18d30, 0xa960, 0x1d0
.long 0x480, 0x18d90, 0xad70, 0x260, 0x490, 0x18d80, 0xb180, 0x2f0
.long 0x4a0, 0x18db0, 0xb590, 0x380, 0x4b0, 0x18da0, 0xb9a0, 0x410
.long 0x500, 0x18e20, 0xbdb0, 0x4a0, 0x510, 0x18e30, 0xc1c0, 0x530
.long 0x520, 0x18e00, 0xc5d0, 0x5c0, 0x530, 0x18e10, 0xc9e0, 0x650
.long 0x580, 0x18eb0, 0xcdf0, 0x6e0, 0x590, 0x18ea0, 0xd200, 0x770
.long 0x5a0, 0x18e90, 0xd610, 0x800, 0x5b0, 0x18e80, 0xda20, 0x890
.long 0x600, 0x18f40, 0x9d40, 0x30, 0x610, 0x18f50, 0xa150, 0xc0
.long 0x620, 0x18f60, 0xa560, 0x150, 0x630, 0x18f70, 0xa970, 0x1e0
.long 0x680, 0x18fd0, 0xad80, 0x270, 0x690, 0x18fc0, 0xb190, 0x300
.long 0x6a0, 0x18ff0, 0xb5a0, 0x390, 0x6b0, 0x18fe0, 0xb9b0, 0x420
.long 0x700, 0x19060, 0xbdc0, 0x4b0, 0x710, 0x19070, 0xc1d0, 0x540
.long 0x720, 0x19040, 0xc5e0, 0x5d0, 0x730, 0x19050, 0xc9f0, 0x660
.long 0x780, 0x190f0, 0xce00, 0x6f0, 0x790, 0x190e0, 0xd210, 0x780
.long 0x7a0, 0x190d0, 0xd620, 0x810, 0x7b0, 0x190c0, 0xda30, 0x8a0
.long 0x0, 0x0, 0x9d10, 0x0, 0x80, 0x90, 0xa120, 0x3
.long 0x100, 0x120, 0xa530, 0x6, 0x180, 0x1b0, 0xa940, 0x9
.long 0x200, 0x240, 0xad50, 0xc, 0x280, 0x2d0, 0xb160, 0xf
.long 0x300, 0x360, 0xb570, 0x12, 0x380, 0x3f0, 0xb980, 0x15
.long 0x400, 0x480, 0xbd90, 0x0, 0x480, 0x510, 0xc1a0, 0x3
.long 0x500, 0x5a0, 0xc5b0, 0x6, 0x580, 0x630, 0xc9c0, 0x9
.long 0x600, 0x6c0, 0xcdd0, 0xc, 0x680, 0x750, 0xd1e0, 0xf
.long 0x700, 0x7e0, 0xd5f0, 0x12, 0x780, 0x870, 0xda00, 0x15
.long 0x20, 0x900, 0xde10, 0x0, 0xa0, 0x990, 0xe220, 0x3
.long 0x120, 0xa20, 0xe630, 0x6, 0x1a0, 0xab0, 0xea40, 0x9
.long 0x220, 0xb40, 0xee50, 0xc, 0x2a0, 0xbd0, 0xf260, 0xf
.long 0x320, 0xc60, 0xf670, 0x12, 0x3a0, 0xcf0, 0xfa80, 0x15
.long 0x420, 0xd80, 0xfe90, 0x0, 0x4a0, 0xe10, 0x102a0, 0x3
.long 0x520, 0xea0, 0x106b0, 0x6, 0x5a0, 0xf30, 0x10ac0, 0x9
.long 0x620, 0xfc0, 0x10ed0, 0xc, 0x6a0, 0x1050, 0x112e0, 0xf
.long 0x720, 0x10e0, 0x116f0, 0x12, 0x7a0, 0x1170, 0x11b00, 0x15
.long 0x10, 0x1200, 0x11f10, 0x0, 0x90, 0x1290, 0x12320, 0x3
.long 0x110, 0x1320, 0x12730, 0x6, 0x190, 0x13b0, 0x12b40, 0x9
.long 0x210, 0x1440, 0x12f50, 0xc, 0x290, 0x14d0, 0x13360, 0xf
.long 0x310, 0x1560, 0x13770, 0x12, 0x390, 0x15f0, 0x13b80, 0x15
.long 0x410, 0x1680, 0x13f90, 0x0, 0x490, 0x1710, 0x143a0, 0x3
.long 0x510, 0x17a0, 0x147b0, 0x6, 0x590, 0x1830, 0x14bc0, 0x9
.long 0x610, 0x18c0, 0x14fd0, 0xc, 0x690, 0x1950, 0x153e0, 0xf
.long 0x710, 0x19e0, 0x157f0, 0x12, 0x790, 0x1a70, 0x15c00, 0x15
.long 0x30, 0x1b00, 0x16010, 0x0, 0xb0, 0x1b90, 0x16420, 0x3
.long 0x130, 0x1c20, 0x16830, 0x6, 0x1b0, 0x1cb0, 0x16c40, 0x9
.long 0x230, 0x1d40, 0x17050, 0xc, 0x2b0, 0x1dd0, 0x17460, 0xf
.long 0x330, 0x1e60, 0x17870, 0x12, 0x3b0, 0x1ef0, 0x17c80, 0x15
.long 0x430, 0x1f80, 0x18090, 0x0, 0x4b0, 0x2010, 0x184a0, 0x3
.long 0x530, 0x20a0, 0x188b0, 0x6, 0x5b0, 0x2130, 0x18cc0, 0x9
.long 0x630, 0x21c0, 0x190d0, 0xc, 0x6b0, 0x2250, 0x194e0, 0xf
.long 0x730, 0x22e0, 0x198f0, 0x12, 0x7b0, 0x2370, 0x19d00, 0x15
.long 0x0, 0x9e3779b1, 0x0, 0x9e3779b1, 0x0, 0x9e3779b1, 0x10, 0x85ebca6b
.long 0x0, 0x9e3779b1, 0x20, 0x9e3779b1, 0x0, 0x9e3779b1, 0x30, 0x85ebca6b
.long 0x1, 0x85ebca6b, 0x110, 0x9e3779b1, 0x1, 0x85ebca6b, 0x120, 0x85ebca6b
.long 0x1, 0x85ebca6b, 0x130, 0x9e3779b1, 0x1, 0x85ebca6b, 0x140, 0x85ebca6b
.long 0x2, 0x9e3779b1, 0x220, 0x9e3779b1, 0x2, 0x9e3779b1, 0x230, 0x85ebca6b
.long 0x2, 0x9e3779b1, 0x240, 0x9e3779b1, 0x2, 0x9e3779b1, 0x250, 0x85ebca6b
.long 0x3, 0x85ebca6b, 0x330, 0x9e3779b1, 0x3, 0x85ebca6b, 0x340, 0x85ebca6b
.long 0x3, 0x85ebca6b, 0x350, 0x9e3779b1, 0x3, 0x85ebca6b, 0x360, 0x85ebca6b
.long 0x4, 0x9e3779b1, 0x440, 0x9e3779b1, 0x4, 0x9e3779b1, 0x450, 0x85ebca6b
.long 0x4, 0x9e3779b1, 0x460, 0x9e3779b1, 0x4, 0x9e3779b1, 0x470, 0x85ebca6b
.long 0x5, 0x85ebca6b, 0x550, 0x9e3779b1, 0x5, 0x85ebca6b, 0x560, 0x85ebca6b
.long 0x5, 0x85ebca6b, 0x570, 0x9e3779b1, 0x5, 0x85ebca6b, 0x580, 0x85ebca6b
.long 0x6, 0x9e3779b1, 0x660, 0x9e3779b1, 0x6, 0x9e3779b1, 0x670, 0x85ebca6b
.long 0x6, 0x9e3779b1, 0x680, 0x9e3779b1, 0x6, 0x9e3779b1, 0x690, 0x85ebca6b
.long 0x7, 0x85ebca6b, 0x770, 0x9e3779b1, 0x7, 0x85ebca6b, 0x780, 0x85ebca6b
.long 0x7, 0x85ebca6b, 0x790, 0x9e3779b1, 0x7, 0x85ebca6b, 0x7a0, 0x85ebca6b
.long 0x0, 0x9e3779b1, 0x40, 0x9e3779b1, 0x0, 0x9e3779b1, 0x50, 0x85ebca6b
.long 0x0, 0x9e3779b1, 0x60, 0x9e3779b1, 0x0, 0x9e3779b1, 0x70, 0x85ebca6b
.long 0x1, 0x85ebca6b, 0x150, 0x9e3779b1, 0x1, 0x85ebca6b, 0x160, 0x85ebca6b
.long 0x1, 0x85ebca6b, 0x170, 0x9e3779b1, 0x1, 0x85ebca6b, 0x180, 0x85ebca6b
.long 0x2, 0x9e3779b1, 0x260, 0x9e3779b1, 0x2, 0x9e3779b1, 0x270, 0x85ebca6b
.long 0x2, 0x9e3779b1, 0x280, 0x9e3779b1, 0x2, 0x9e3779b1, 0x290, 0x85ebca6b
.long 0x3, 0x85ebca6b, 0x370, 0x9e3779b1, 0x3, 0x85ebca6b, 0x380, 0x85ebca6b
.long 0x3, 0x85ebca6b, 0x390, 0x9e3779b1, 0x3, 0x85ebca6b, 0x3a0, 0x85ebca6b
.long 0x4, 0x9e3779b1, 0x480, 0x9e3779b1, 0x4, 0x9e3779b1, 0x490, 0x85ebca6b
.long 0x4, 0x9e3779b1, 0x4a0, 0x9e3779b1, 0x4, 0x9e3779b1, 0x4b0, 0x85ebca6b
.long 0x5, 0x85ebca6b, 0x590, 0x9e3779b1, 0x5, 0x85ebca6b, 0x5a0, 0x85ebca6b
.long 0x5, 0x85ebca6b, 0x5b0, 0x9e3779b1, 0x5, 0x85ebca6b, 0x5c0, 0x85ebca6b
.long 0x6, 0x9e3779b1, 0x6a0, 0x9e3779b1, 0x6, 0x9e3779b1, 0x6b0, 0x85ebca6b
.long 0x6, 0x9e3779b1, 0x6c0, 0x9e3779b1, 0x6, 0x9e3779b1, 0x6d0, 0x85ebca6b
.long 0x7, 0x85ebca6b, 0x7b0, 0x9e3779b1, 0x7, 0x85ebca6b, 0x7c0, 0x85ebca6b
.long 0x7, 0x85ebca6b, 0x7d0, 0x9e3779b1, 0x7, 0x85ebca6b, 0x7e0, 0x85ebca6b
.section .rodata,"a"
.p2align 6
.amdhsa_kernel gather_scatter__mpnn_edge_mlp__graph_kernel
  .amdhsa_next_free_vgpr 256
  .amdhsa_next_free_sgpr 102
  .amdhsa_accum_offset 256
  .amdhsa_group_segment_fixed_size 0
  .amdhsa_kernarg_size 72
  .amdhsa_user_sgpr_count 2
  .amdhsa_user_sgpr_kernarg_segment_ptr 1
  .amdhsa_system_sgpr_workgroup_id_x 1
.end_amdhsa_kernel
```
